```python
import torch

def _softmax(x, axis=-1):
    return torch.softmax(x, dim=axis)
def _gelu(x):
    return torch.nn.functional.gelu(x, approximate="tanh")
def _silu(x):
    return torch.nn.functional.silu(x)
def _sigmoid(x):
    return torch.sigmoid(x)
def _layernorm(x, axis=-1, eps=1e-5):
    m = x.mean(dim=axis, keepdim=True)
    v = x.var(dim=axis, keepdim=True, unbiased=False)
    return (x - m) / torch.sqrt(v + eps)
def _scatter_add(tgt, idx, src, axis=0):
    return tgt.clone().index_add_(axis, idx, src)
def _segment_sum(src, seg, n):
    out = torch.zeros((n,) + src.shape[1:], dtype=src.dtype)
    return out.index_add_(0, seg, src)
def _pad(x, pw):
    flat = tuple(v for pair in reversed(pw) for v in pair)
    return torch.nn.functional.pad(x, flat)

kernel_name = 'gated_mix__sliding_block_cached__glu_gated_reglu__decode'

def setup_inputs():

    _w = (lambda a: (lambda t: t.to(torch.bfloat16) if t.is_floating_point() else t)(torch.as_tensor(a)))
    def _A_setup():
        B, Sq, D = 4, 1, 576
        Hq, Hkv, Sk, Dh = 32, 16, 4096, 128
        assert Hq % Hkv == 0, (Hq, Hkv)
        return {
            "x": _w((lambda *s: torch.randn(*s, dtype=torch.bfloat16) * 0.05)(B, Sq, D)),
            "k_cache": _w((lambda *s: torch.randn(*s, dtype=torch.bfloat16) * 3.2)(B, Hkv, Sk, Dh)),
            "v_cache": _w((lambda *s: torch.randn(*s, dtype=torch.bfloat16) * 0.05)(B, Hkv, Sk, Dh)),
            "wq": _w((lambda *s: torch.randn(*s, dtype=torch.bfloat16) * 3.2)(D, Hq * Dh) * (D ** -0.5)),
            "wo": _w((lambda *s: torch.randn(*s, dtype=torch.bfloat16) * 0.05)(Hq * Dh, D) * ((Hq * Dh) ** -0.5)),
        }
    _A_in = _A_setup()

    def _B_setup():
        B, S, D, F = 4, 1, 576, 4608
        return {
            "x": _w((lambda *s: torch.randn(*s, dtype=torch.bfloat16) * 0.05)(B, S, D)),
            "W_gate": _w((lambda *s: torch.randn(*s, dtype=torch.bfloat16) * 0.2)(D, F) * (2.0 / D) ** 0.5),
            "W_up": _w((lambda *s: torch.randn(*s, dtype=torch.bfloat16) * 0.2)(D, F) * (2.0 / D) ** 0.5),
            "W_down": _w((lambda *s: torch.randn(*s, dtype=torch.bfloat16) * 0.2)(F, D) * (1.0 / F) ** 0.5),
        }
    _B_in = _B_setup()

    return {
        "A_x": _A_in["x"],
        "A_k_cache": _A_in["k_cache"],
        "A_v_cache": _A_in["v_cache"],
        "A_wq": _A_in["wq"],
        "A_wo": _A_in["wo"],
        "B_x": _B_in["x"],
        "B_W_gate": _B_in["W_gate"],
        "B_W_up": _B_in["W_up"],
        "B_W_down": _B_in["W_down"],
        "gate_w": _w((lambda *s: torch.randn(*s, dtype=torch.bfloat16) * 0.05)(576) * 16.0),
    }

def reference(A_x, A_k_cache, A_v_cache, A_wq, A_wo, B_x, B_W_gate, B_W_up, B_W_down, gate_w):
    def _A_ref(x, k_cache, v_cache, wq, wo):
        B, Sq, D = x.shape
        Hq, Dh = 32, 128
        Hkv, Sk = k_cache.shape[1], k_cache.shape[2]
        W = min(4096, max(256, Sk // 4))
        rep = Hq // Hkv
        q = (lambda x, *d: x.permute(*d))((x @ wq).reshape(B, Sq, Hq, Dh), 0, 2, 1, 3)
        k = (lambda x, n, axis: torch.repeat_interleave(x, n, dim=axis))(k_cache[:, :, Sk - W:, :], rep, axis=1)
        v = (lambda x, n, axis: torch.repeat_interleave(x, n, dim=axis))(v_cache[:, :, Sk - W:, :], rep, axis=1)
        scores = torch.einsum("bhqd,bhkd->bhqk", q, k) * (Dh ** -0.5)
        p = _softmax(scores, axis=-1)
        o = torch.einsum("bhqk,bhkd->bhqd", p, v)
        return (lambda x, *d: x.permute(*d))(o, 0, 2, 1, 3).reshape(B, Sq, Hq * Dh) @ wo

    def _B_ref(x, W_gate, W_up, W_down):
        gate = torch.einsum("bsd,df->bsf", x, W_gate)
        up = torch.einsum("bsd,df->bsf", x, W_up)
        gate = gate * (lambda x, dt: x.to(dt))(gate > 0, gate.dtype)
        h = gate * up
        return torch.einsum("bsf,fd->bsd", h, W_down)

    x = A_x
    g = _sigmoid((x * gate_w).sum(-1, keepdims=True))
    a = _A_ref(x, A_k_cache, A_v_cache, A_wq, A_wo)
    b = _B_ref(x, B_W_gate, B_W_up, B_W_down)
    return g * a + (1 - g) * b
```

```asm
; @launch grid=(256,1,1) block=(512,1,1) lds=158720
.amdgcn_target "amdgcn-amd-amdhsa--gfx950"
.text
.globl gated_mix__sliding_block_cached__glu_gated_reglu__decode_kernel
.p2align 8
.type gated_mix__sliding_block_cached__glu_gated_reglu__decode_kernel,@function
gated_mix__sliding_block_cached__glu_gated_reglu__decode_kernel:
s_cmpk_ge_u32 s2, 0x100
s_cbranch_scc1 L_exit
s_lshr_b32 s46, s2, 3
s_and_b32 s45, s46, 15
s_lshr_b32 s49, s46, 4
s_lshl3_add_u32 s56, s49, 48
s_lshl_b32 s57, s49, 2
s_cmp_lt_u32 s45, 4
s_cselect_b32 s56, 24, s56
s_load_dwordx2 s[16:17], s[0:1], s56
v_lshrrev_b32 v1, 6, v0
s_cselect_b32 s53, 8, 9
s_cselect_b32 s57, s57, -4
v_readfirstlane_b32 s3, v1
s_and_b32 s47, s2, 7
s_lshl1_add_u32 s44, s47, s49
s_cmp_eq_u32 s3, 7
s_cbranch_scc1 L_x
s_cmp_ge_u32 s3, 4
s_cbranch_scc1 L_t
v_and_b32 v0, 63, v0
s_cmp_ge_u32 s45, 13
s_cbranch_scc1 L_mn
s_mul_i32 s54, s47, s53
s_add_u32 s54, s54, s45
s_add_u32 s54, s54, s57
s_lshl_b32 s58, s53, 13
s_lshl_b32 s53, s53, 10
s_mul_i32 s18, s53, 576
s_lshl_b32 s19, 1, 17
s_mul_i32 s57, s3, 18
s_lshl_b32 m0, s57, 10
s_mul_i32 s57, s57, s58
s_lshl_b32 s56, s54, 7
s_add_u32 s50, s56, s57
v_lshrrev_b32 v1, 3, v0
v_and_b32 v2, 2, v1
v_and_b32 v3, 7, v0
v_xor_b32 v2, v2, v3
v_lshlrev_b32 v2, 4, v2
v_mad_u32_u24 v10, v1, s53, v2
v_xor_b32 v11, 64, v10
s_waitcnt lgkmcnt(0)
buffer_load_dwordx4 v10, s[16:19], s50 offen nt lds
s_addk_i32 m0, 0x400
s_add_u32 s50, s50, s58
buffer_load_dwordx4 v11, s[16:19], s50 offen nt lds
s_addk_i32 m0, 0x400
s_add_u32 s50, s50, s58
buffer_load_dwordx4 v10, s[16:19], s50 offen nt lds
s_addk_i32 m0, 0x400
s_add_u32 s50, s50, s58
buffer_load_dwordx4 v11, s[16:19], s50 offen nt lds
s_addk_i32 m0, 0x400
s_add_u32 s50, s50, s58
buffer_load_dwordx4 v10, s[16:19], s50 offen nt lds
s_load_dwordx2 s[8:9], s[0:1], 8
s_load_dwordx2 s[24:25], s[0:1], 32
s_load_dwordx2 s[32:33], s[0:1], 96
s_mul_i32 s51, s3, 18432
s_waitcnt vmcnt(4)
s_addk_i32 m0, 0x400
s_add_u32 s50, s50, s58
buffer_load_dwordx4 v11, s[16:19], s50 offen nt lds
s_lshr_b32 s56, s45, 2
s_lshl4_add_u32 s52, s56, s44
s_lshl_b32 s52, s52, 20
s_and_b32 s56, s45, 3
s_lshl2_add_u32 s56, s56, s3
s_add_u32 s56, s56, 48
s_lshl_b32 s56, s56, 14
s_add_u32 s52, s52, s56
s_lshr_b32 s56, s46, 2
s_add_u32 s56, s56, s46
s_add_u32 s57, s56, 0
s_and_b32 s57, s57, 3
s_lshl_b32 s57, s57, 12
s_add_u32 s40, s52, s57
s_add_u32 s57, s56, 1
s_and_b32 s57, s57, 3
s_lshl_b32 s57, s57, 12
s_add_u32 s41, s52, s57
s_add_u32 s57, s56, 2
s_and_b32 s57, s57, 3
s_lshl_b32 s57, s57, 12
s_add_u32 s42, s52, s57
s_add_u32 s57, s56, 3
s_and_b32 s57, s57, 3
s_lshl_b32 s57, s57, 12
s_add_u32 s43, s52, s57
s_lshl_b32 s28, s3, 14
s_add_u32 s28, s28, 73728
s_mov_b32 s10, 67108864
s_mov_b32 s11, 0x20000
v_lshrrev_b32 v4, 4, v0
v_and_b32 v5, 15, v0
v_lshlrev_b32 v6, 2, v4
v_xor_b32 v6, v6, v5
v_lshlrev_b32 v6, 4, v6
v_lshl_add_u32 v12, v4, 8, v6
v_xor_b32 v13, 16, v12
v_xor_b32 v14, 32, v12
v_xor_b32 v15, 48, v12
s_load_dwordx2 s[12:13], s[0:1], 16
s_mov_b32 s14, 67108864
s_mov_b32 s15, 0x20000
v_lshlrev_b32 v16, 4, v0
s_waitcnt vmcnt(4)
s_addk_i32 m0, 0x400
s_add_u32 s50, s50, s58
buffer_load_dwordx4 v10, s[16:19], s50 offen nt lds
s_waitcnt lgkmcnt(0)
s_waitcnt vmcnt(4)
s_addk_i32 m0, 0x400
s_add_u32 s50, s50, s58
buffer_load_dwordx4 v11, s[16:19], s50 offen nt lds
v_lshrrev_b32 v4, 4, v0
v_bfe_u32 v1, v0, 2, 2
v_mul_u32_u24 v1, 0x480, v1
s_mul_i32 s56, s3, 288
s_add_u32 s56, s56, 151552
v_add_u32 v1, s56, v1
v_lshl_add_u32 v24, v4, 4, v1
v_and_b32 v5, 1, v4
v_lshlrev_b32 v5, 4, v5
v_lshrrev_b32 v6, 1, v4
v_lshl_add_u32 v5, v6, 3, v5
v_add_u32 v40, v1, v5
s_waitcnt vmcnt(4)
s_add_u32 m0, s28, 0
s_mov_b32 s29, s40
buffer_load_dwordx4 v12, s[8:11], s29 offen nt lds
v_lshrrev_b32 v4, 4, v0
v_bfe_u32 v5, v0, 2, 2
v_and_b32 v6, 3, v0
v_lshl_add_u32 v7, v4, 3, v5
v_lshlrev_b32 v7, 7, v7
v_lshl_add_u32 v7, v6, 3, v7
v_add_u32 v7, s51, v7
v_and_b32 v8, 1, v4
v_lshrrev_b32 v9, 1, v5
v_lshl_add_u32 v8, v8, 1, v9
v_lshl_add_u32 v17, v8, 5, v7
v_xor_b32 v18, 32, v17
v_xor_b32 v19, 64, v17
v_xor_b32 v20, 0x60, v17
s_waitcnt vmcnt(4)
s_add_u32 m0, s51, 8192
s_add_u32 s50, s50, s58
buffer_load_dwordx4 v10, s[16:19], s50 offen nt lds
v_mov_b32 v22, 148640
v_mov_b32 v23, 1
s_waitcnt lgkmcnt(0)
s_barrier
s_waitcnt vmcnt(4)
s_addk_i32 m0, 0x400
s_add_u32 s50, s50, s58
buffer_load_dwordx4 v11, s[16:19], s50 offen nt lds
s_waitcnt vmcnt(4)
s_addk_i32 m0, 0x400
s_add_u32 s50, s50, s58
buffer_load_dwordx4 v10, s[16:19], s50 offen nt lds
s_waitcnt vmcnt(4)
s_addk_i32 m0, 0x400
s_add_u32 s50, s50, s58
buffer_load_dwordx4 v11, s[16:19], s50 offen nt lds
s_waitcnt vmcnt(4)
s_add_u32 m0, s28, 0
s_mov_b32 s29, s40
buffer_load_dwordx4 v13, s[8:11], s29 offen offset:1024 nt lds
s_waitcnt vmcnt(4)
s_add_u32 m0, s51, 12288
s_add_u32 s50, s50, s58
buffer_load_dwordx4 v10, s[16:19], s50 offen nt lds
L_wx:
ds_read_b32 v1, v22 offset:20
s_waitcnt lgkmcnt(0)
v_readfirstlane_b32 s4, v1
s_cmp_lt_u32 s4, 1
s_cbranch_scc1 L_wx
ds_read_b64 v[40:41], v40 offset:256
ds_read_b128 v[36:39], v24 offset:192
ds_read_b128 v[32:35], v24 offset:128
ds_read_b128 v[28:31], v24 offset:64
ds_read_b128 v[24:27], v24 offset:0
ds_read_b64_tr_b16 v[60:61], v17 offset:0
ds_read_b64_tr_b16 v[62:63], v17 offset:512
ds_read_b64_tr_b16 v[64:65], v18 offset:0
ds_read_b64_tr_b16 v[66:67], v18 offset:512
ds_read_b64_tr_b16 v[68:69], v19 offset:0
ds_read_b64_tr_b16 v[70:71], v19 offset:512
ds_read_b64_tr_b16 v[72:73], v20 offset:0
ds_read_b64_tr_b16 v[74:75], v20 offset:512
s_waitcnt lgkmcnt(6)
v_mfma_f32_16x16x32_bf16 v[44:47], v[24:27], v[60:63], 0
s_waitcnt lgkmcnt(4)
v_mfma_f32_16x16x32_bf16 v[48:51], v[24:27], v[64:67], 0
s_waitcnt lgkmcnt(2)
v_mfma_f32_16x16x32_bf16 v[52:55], v[24:27], v[68:71], 0
s_waitcnt lgkmcnt(0)
v_mfma_f32_16x16x32_bf16 v[56:59], v[24:27], v[72:75], 0
s_waitcnt vmcnt(4)
s_addk_i32 m0, 0x400
s_add_u32 s50, s50, s58
buffer_load_dwordx4 v11, s[16:19], s50 offen nt lds
ds_read_b64_tr_b16 v[76:77], v17 offset:4096
ds_read_b64_tr_b16 v[78:79], v17 offset:4608
ds_read_b64_tr_b16 v[80:81], v18 offset:4096
ds_read_b64_tr_b16 v[82:83], v18 offset:4608
ds_read_b64_tr_b16 v[84:85], v19 offset:4096
ds_read_b64_tr_b16 v[86:87], v19 offset:4608
ds_read_b64_tr_b16 v[88:89], v20 offset:4096
ds_read_b64_tr_b16 v[90:91], v20 offset:4608
s_waitcnt lgkmcnt(6)
v_mfma_f32_16x16x32_bf16 v[44:47], v[28:31], v[76:79], v[44:47]
s_waitcnt lgkmcnt(4)
v_mfma_f32_16x16x32_bf16 v[48:51], v[28:31], v[80:83], v[48:51]
s_waitcnt lgkmcnt(2)
v_mfma_f32_16x16x32_bf16 v[52:55], v[28:31], v[84:87], v[52:55]
s_waitcnt lgkmcnt(0)
v_mfma_f32_16x16x32_bf16 v[56:59], v[28:31], v[88:91], v[56:59]
s_waitcnt vmcnt(4)
s_addk_i32 m0, 0x400
s_add_u32 s50, s50, s58
buffer_load_dwordx4 v10, s[16:19], s50 offen nt lds
s_waitcnt vmcnt(4)
s_addk_i32 m0, 0x400
s_add_u32 s50, s50, s58
buffer_load_dwordx4 v11, s[16:19], s50 offen nt lds
ds_read_b64_tr_b16 v[60:61], v17 offset:8192
ds_read_b64_tr_b16 v[62:63], v17 offset:8704
ds_read_b64_tr_b16 v[64:65], v18 offset:8192
ds_read_b64_tr_b16 v[66:67], v18 offset:8704
ds_read_b64_tr_b16 v[68:69], v19 offset:8192
ds_read_b64_tr_b16 v[70:71], v19 offset:8704
ds_read_b64_tr_b16 v[72:73], v20 offset:8192
ds_read_b64_tr_b16 v[74:75], v20 offset:8704
s_waitcnt lgkmcnt(6)
v_mfma_f32_16x16x32_bf16 v[44:47], v[32:35], v[60:63], v[44:47]
s_waitcnt lgkmcnt(4)
v_mfma_f32_16x16x32_bf16 v[48:51], v[32:35], v[64:67], v[48:51]
s_waitcnt lgkmcnt(2)
v_mfma_f32_16x16x32_bf16 v[52:55], v[32:35], v[68:71], v[52:55]
s_waitcnt lgkmcnt(0)
v_mfma_f32_16x16x32_bf16 v[56:59], v[32:35], v[72:75], v[56:59]
s_waitcnt vmcnt(4)
s_add_u32 m0, s28, 0
s_mov_b32 s29, s40
buffer_load_dwordx4 v14, s[8:11], s29 offen offset:2048 nt lds
s_waitcnt vmcnt(4)
s_add_u32 m0, s51, 16384
s_add_u32 s50, s50, s58
buffer_load_dwordx4 v10, s[16:19], s50 offen nt lds
s_waitcnt vmcnt(4)
s_addk_i32 m0, 0x400
s_add_u32 s50, s50, s58
buffer_load_dwordx4 v11, s[16:19], s50 offen nt lds
s_add_u32 m0, s28, 0
s_mov_b32 s29, s40
buffer_load_dwordx4 v15, s[8:11], s29 offen offset:3072 nt lds
s_waitcnt vmcnt(5)
s_add_u32 m0, s28, 4096
s_mov_b32 s29, s41
buffer_load_dwordx4 v12, s[8:11], s29 offen nt lds
s_waitcnt vmcnt(5)
buffer_load_dwordx4 v13, s[8:11], s29 offen offset:1024 nt lds
ds_read_b64_tr_b16 v[76:77], v17 offset:12288
ds_read_b64_tr_b16 v[78:79], v17 offset:12800
ds_read_b64_tr_b16 v[80:81], v18 offset:12288
ds_read_b64_tr_b16 v[82:83], v18 offset:12800
ds_read_b64_tr_b16 v[84:85], v19 offset:12288
ds_read_b64_tr_b16 v[86:87], v19 offset:12800
ds_read_b64_tr_b16 v[88:89], v20 offset:12288
ds_read_b64_tr_b16 v[90:91], v20 offset:12800
s_waitcnt lgkmcnt(6)
v_mfma_f32_16x16x32_bf16 v[44:47], v[36:39], v[76:79], v[44:47]
s_waitcnt lgkmcnt(4)
v_mfma_f32_16x16x32_bf16 v[48:51], v[36:39], v[80:83], v[48:51]
s_waitcnt lgkmcnt(2)
v_mfma_f32_16x16x32_bf16 v[52:55], v[36:39], v[84:87], v[52:55]
s_waitcnt lgkmcnt(0)
v_mfma_f32_16x16x32_bf16 v[56:59], v[36:39], v[88:91], v[56:59]
v_lshrrev_b32 v4, 4, v0
v_and_b32 v5, 1, v4
v_lshrrev_b32 v6, 1, v4
v_sub_u32 v5, v5, v4
v_lshlrev_b32 v5, 10, v5
v_lshl_add_u32 v5, v6, 9, v5
v_add_u32 v17, v5, v17
v_add_u32 v18, v5, v18
v_add_u32 v19, v5, v19
v_add_u32 v20, v5, v20
s_lshl_b32 s56, s3, 10
s_add_u32 s56, s56, 139264
v_lshl_add_u32 v5, v0, 4, s56
s_waitcnt vmcnt(5)
buffer_load_dwordx4 v14, s[8:11], s29 offen offset:2048 nt lds
s_waitcnt vmcnt(5)
buffer_load_dwordx4 v15, s[8:11], s29 offen offset:3072 nt lds
s_waitcnt vmcnt(5)
s_add_u32 m0, s28, 8192
s_mov_b32 s29, s42
buffer_load_dwordx4 v12, s[8:11], s29 offen nt lds
ds_read_b64_tr_b16 v[60:61], v17 offset:16384
ds_read_b64_tr_b16 v[62:63], v18 offset:16384
ds_read_b64_tr_b16 v[64:65], v19 offset:16384
ds_read_b64_tr_b16 v[66:67], v20 offset:16384
s_waitcnt lgkmcnt(3)
v_mfma_f32_16x16x16_bf16 v[44:47], v[40:41], v[60:61], v[44:47]
s_waitcnt lgkmcnt(2)
v_mfma_f32_16x16x16_bf16 v[48:51], v[40:41], v[62:63], v[48:51]
s_waitcnt lgkmcnt(1)
v_mfma_f32_16x16x16_bf16 v[52:55], v[40:41], v[64:65], v[52:55]
s_waitcnt lgkmcnt(0)
v_mfma_f32_16x16x16_bf16 v[56:59], v[40:41], v[66:67], v[56:59]
s_nop 4
ds_write2_b32 v5, v44, v48 offset0:0 offset1:1
s_nop 1
ds_write2_b32 v5, v52, v56 offset0:2 offset1:3
s_mov_b64 exec, 1
ds_add_u32 v22, v23 offset:0
s_mov_b64 exec, -1
s_waitcnt vmcnt(5)
buffer_load_dwordx4 v13, s[8:11], s29 offen offset:1024 nt lds
s_waitcnt vmcnt(5)
buffer_load_dwordx4 v14, s[8:11], s29 offen offset:2048 nt lds
s_waitcnt vmcnt(5)
buffer_load_dwordx4 v15, s[8:11], s29 offen offset:3072 nt lds
s_waitcnt vmcnt(5)
s_add_u32 m0, s28, 12288
s_mov_b32 s29, s43
buffer_load_dwordx4 v12, s[8:11], s29 offen nt lds
s_waitcnt vmcnt(5)
buffer_load_dwordx4 v13, s[8:11], s29 offen offset:1024 nt lds
s_waitcnt vmcnt(5)
buffer_load_dwordx4 v14, s[8:11], s29 offen offset:2048 nt lds
s_waitcnt vmcnt(5)
buffer_load_dwordx4 v15, s[8:11], s29 offen offset:3072 nt lds
s_waitcnt vmcnt(5)
s_mov_b32 s60, s40
buffer_load_dwordx4 v[116:119], v16, s[12:15], s60 offen nt
s_mov_b32 s34, 1036288
s_mov_b32 s35, 0x20000
s_mov_b32 s26, 4718592
s_mov_b32 s27, 0x20000
s_mov_b32 s58, s60
s_lshr_b32 s56, 0x8080, s47
s_and_b32 s56, s56, 0x1ff0
s_cmp_eq_u32 s49, 0
s_cselect_b32 s57, 8, 0
s_or_b32 s56, s56, s57
s_bfm_b32 s57, s45, 0
s_andn2_b32 s57, s57, s56
s_bcnt1_i32_b32 s30, s57
s_min_u32 s57, s30, 9
s_sub_u32 s60, s45, s57
s_bitcmp1_b32 s56, s45
s_cselect_b32 s30, 9, s30
s_mov_b32 s60, s58
s_movk_i32 s56, 0x480
v_lshrrev_b32 v1, 3, v0
v_and_b32 v2, 2, v1
v_and_b32 v3, 7, v0
v_xor_b32 v2, v2, v3
v_lshlrev_b32 v2, 4, v2
v_mad_u32_u24 v10, v1, s56, v2
v_xor_b32 v11, 64, v10
v_lshrrev_b32 v4, 4, v0
v_bfe_u32 v5, v0, 2, 2
v_and_b32 v6, 3, v0
v_lshl_add_u32 v7, v4, 3, v5
v_lshlrev_b32 v7, 7, v7
v_lshl_add_u32 v7, v6, 3, v7
v_add_u32 v7, s51, v7
v_and_b32 v8, 1, v4
v_lshrrev_b32 v9, 1, v5
v_lshl_add_u32 v8, v8, 1, v9
v_lshl_add_u32 v17, v8, 5, v7
v_xor_b32 v18, 32, v17
v_xor_b32 v19, 64, v17
v_xor_b32 v20, 0x60, v17
s_lshl2_add_u32 s54, s44, s3
s_mul_i32 s50, s54, 73728
s_lshl_b32 s54, s54, 12
s_mov_b32 s62, 0x05040100
s_mov_b32 s96, 0xffff0000
s_mov_b32 s97, 0x7060500
s_mov_b32 s98, 0x7060501
s_mov_b32 s99, 0x7060502
s_mov_b32 s100, 0x7060503
v_lshrrev_b32 v4, 4, v0
v_lshlrev_b32 v4, 2, v4
v_add_u32 v42, 147968, v4
v_mov_b32 v21, 148000
s_waitcnt vmcnt(5)
buffer_load_dwordx4 v[120:123], v16, s[12:15], s60 offen offset:1024 nt
v_and_b32 v5, 15, v0
v_lshrrev_b32 v4, 4, v0
v_xor_b32 v6, v4, v5
v_lshlrev_b32 v6, 4, v6
v_and_b32 v7, 3, v5
v_lshl_add_u32 v6, v7, 10, v6
v_lshrrev_b32 v7, 2, v5
v_lshl_add_u32 v6, v7, 8, v6
v_add_u32 v12, s28, v6
v_xor_b32 v13, 64, v12
v_xor_b32 v14, 0x80, v12
v_xor_b32 v15, 0xc0, v12
v_lshrrev_b32 v7, 3, v5
v_lshlrev_b32 v8, 8, v7
v_lshl_add_u32 v8, v4, 4, v8
v_add_u32 v8, 147456, v8
s_lshl_b32 s56, s3, 2
s_add_u32 s56, s56, 148544
v_lshl_add_u32 v7, v7, 4, s56
v_lshrrev_b32 v6, 1, v4
v_and_b32 v4, 1, v4
v_lshlrev_b32 v6, 9, v6
v_lshl_add_u32 v6, v5, 5, v6
v_lshl_add_u32 v6, v4, 4, v6
s_lshl_b32 s56, s3, 10
s_add_u32 s56, s56, 143360
v_add_u32 v9, s56, v6
v_and_b32 v1, 1, v0
v_lshlrev_b32 v1, 4, v1
v_mov_b32 v2, 0xffff
v_lshlrev_b32 v1, v1, v2
v_bfe_u32 v2, v0, 1, 2
v_cmp_eq_u32 s[4:5], 0, v2
s_nop 1
v_cndmask_b32 v108, 0, v1, s[4:5]
v_cmp_eq_u32 s[4:5], 1, v2
s_nop 1
v_cndmask_b32 v109, 0, v1, s[4:5]
v_cmp_eq_u32 s[4:5], 2, v2
s_nop 1
v_cndmask_b32 v110, 0, v1, s[4:5]
v_cmp_eq_u32 s[4:5], 3, v2
s_nop 1
v_cndmask_b32 v111, 0, v1, s[4:5]
s_waitcnt vmcnt(5)
buffer_load_dwordx4 v[124:127], v16, s[12:15], s60 offen offset:2048 nt
s_waitcnt vmcnt(5)
buffer_load_dwordx4 v[128:131], v16, s[12:15], s60 offen offset:3072 nt
s_waitcnt vmcnt(5)
s_mov_b32 s60, s41
buffer_load_dwordx4 v[132:135], v16, s[12:15], s60 offen nt
s_waitcnt vmcnt(5)
buffer_load_dwordx4 v[136:139], v16, s[12:15], s60 offen offset:1024 nt
s_waitcnt vmcnt(5)
buffer_load_dwordx4 v[140:143], v16, s[12:15], s60 offen offset:2048 nt
s_waitcnt vmcnt(5)
buffer_load_dwordx4 v[144:147], v16, s[12:15], s60 offen offset:3072 nt
s_waitcnt vmcnt(5)
s_mov_b32 s60, s42
buffer_load_dwordx4 v[148:151], v16, s[12:15], s60 offen nt
s_waitcnt vmcnt(5)
buffer_load_dwordx4 v[152:155], v16, s[12:15], s60 offen offset:1024 nt
s_waitcnt vmcnt(5)
buffer_load_dwordx4 v[156:159], v16, s[12:15], s60 offen offset:2048 nt
ds_read_b128 v[60:63], v12 offset:0
ds_read_b128 v[64:67], v13 offset:0
ds_read_b128 v[68:71], v14 offset:0
ds_read_b128 v[72:75], v15 offset:0
ds_read_b128 v[76:79], v12 offset:4096
ds_read_b128 v[80:83], v13 offset:4096
ds_read_b128 v[84:87], v14 offset:4096
ds_read_b128 v[88:91], v15 offset:4096
L_wqp:
ds_read_b32 v1, v22 offset:8
ds_read_b128 v[92:95], v8 offset:0
ds_read_b128 v[96:99], v8 offset:64
ds_read_b128 v[100:103], v8 offset:128
ds_read_b128 v[104:107], v8 offset:192
s_waitcnt lgkmcnt(4)
v_readfirstlane_b32 s4, v1
s_cmp_lt_u32 s4, 1
s_cbranch_scc1 L_wqp
ds_read_b32 v42, v42
ds_read_b32 v21, v21
s_add_u32 s54, s54, 217088
s_mov_b32 s56, 0x3e0293ee
s_waitcnt lgkmcnt(0)
v_mfma_f32_16x16x32_bf16 v[44:47], v[60:63], v[92:95], 0
v_mfma_f32_16x16x32_bf16 v[44:47], v[64:67], v[96:99], v[44:47]
v_mfma_f32_16x16x32_bf16 v[44:47], v[68:71], v[100:103], v[44:47]
v_mfma_f32_16x16x32_bf16 v[44:47], v[72:75], v[104:107], v[44:47]
ds_read_b128 v[60:63], v12 offset:8192
ds_read_b128 v[64:67], v13 offset:8192
ds_read_b128 v[68:71], v14 offset:8192
ds_read_b128 v[72:75], v15 offset:8192
v_mfma_f32_16x16x32_bf16 v[48:51], v[76:79], v[92:95], 0
v_mfma_f32_16x16x32_bf16 v[48:51], v[80:83], v[96:99], v[48:51]
v_mfma_f32_16x16x32_bf16 v[48:51], v[84:87], v[100:103], v[48:51]
v_mfma_f32_16x16x32_bf16 v[48:51], v[88:91], v[104:107], v[48:51]
ds_read_b128 v[76:79], v12 offset:12288
ds_read_b128 v[80:83], v13 offset:12288
ds_read_b128 v[84:87], v14 offset:12288
ds_read_b128 v[88:91], v15 offset:12288
s_waitcnt lgkmcnt(4)
v_mfma_f32_16x16x32_bf16 v[52:55], v[60:63], v[92:95], 0
v_mfma_f32_16x16x32_bf16 v[52:55], v[64:67], v[96:99], v[52:55]
v_mfma_f32_16x16x32_bf16 v[52:55], v[68:71], v[100:103], v[52:55]
v_mfma_f32_16x16x32_bf16 v[52:55], v[72:75], v[104:107], v[52:55]
s_waitcnt lgkmcnt(0)
v_mfma_f32_16x16x32_bf16 v[56:59], v[76:79], v[92:95], 0
v_mfma_f32_16x16x32_bf16 v[56:59], v[80:83], v[96:99], v[56:59]
v_mfma_f32_16x16x32_bf16 v[56:59], v[84:87], v[100:103], v[56:59]
v_mfma_f32_16x16x32_bf16 v[56:59], v[88:91], v[104:107], v[56:59]
s_waitcnt vmcnt(5)
buffer_load_dwordx4 v[160:163], v16, s[12:15], s60 offen offset:3072 nt
s_waitcnt vmcnt(5)
s_mov_b32 s60, s43
buffer_load_dwordx4 v[164:167], v16, s[12:15], s60 offen nt
v_max3_f32 v1, v44, v45, v46
v_max3_f32 v1, v1, v47, v48
v_max3_f32 v1, v1, v49, v50
v_max_f32 v1, v1, v51
v_max3_f32 v2, v52, v53, v54
v_max_f32 v2, v2, v55
s_nop 2
v_max3_f32 v1, v1, v56, v57
v_max3_f32 v2, v2, v58, v59
v_max_f32 v1, v1, v2
v_mov_b32 v2, v1
s_nop 1
v_permlane32_swap_b32 v1, v2
v_max_f32 v1, v1, v2
v_mov_b32 v2, v1
s_nop 1
v_permlane16_swap_b32 v1, v2
v_max_f32 v1, v1, v2
v_mul_f32 v3, s56, v1
v_fma_f32 v44, v44, s56, -v3
v_fma_f32 v45, v45, s56, -v3
v_fma_f32 v46, v46, s56, -v3
v_fma_f32 v47, v47, s56, -v3
v_fma_f32 v48, v48, s56, -v3
v_fma_f32 v49, v49, s56, -v3
v_fma_f32 v50, v50, s56, -v3
v_fma_f32 v51, v51, s56, -v3
v_fma_f32 v52, v52, s56, -v3
v_fma_f32 v53, v53, s56, -v3
v_fma_f32 v54, v54, s56, -v3
v_fma_f32 v55, v55, s56, -v3
v_fma_f32 v56, v56, s56, -v3
v_fma_f32 v57, v57, s56, -v3
v_fma_f32 v58, v58, s56, -v3
v_fma_f32 v59, v59, s56, -v3
v_exp_f32 v44, v44
v_exp_f32 v45, v45
v_exp_f32 v46, v46
v_exp_f32 v47, v47
v_exp_f32 v48, v48
v_exp_f32 v49, v49
v_exp_f32 v50, v50
v_exp_f32 v51, v51
v_exp_f32 v52, v52
v_exp_f32 v53, v53
v_exp_f32 v54, v54
v_exp_f32 v55, v55
v_exp_f32 v56, v56
v_exp_f32 v57, v57
v_exp_f32 v58, v58
v_exp_f32 v59, v59
s_waitcnt vmcnt(5)
buffer_load_dwordx4 v[168:171], v16, s[12:15], s60 offen offset:1024 nt
v_add_f32 v1, v44, v45
v_add_f32 v2, v46, v47
v_add_f32 v1, v1, v48
v_add_f32 v2, v2, v49
v_add_f32 v1, v1, v50
v_add_f32 v2, v2, v51
v_add_f32 v1, v1, v52
v_add_f32 v2, v2, v53
v_add_f32 v1, v1, v54
v_add_f32 v2, v2, v55
v_add_f32 v1, v1, v56
v_add_f32 v2, v2, v57
v_add_f32 v1, v1, v58
v_add_f32 v2, v2, v59
v_add_f32 v1, v1, v2
v_mov_b32 v2, v1
s_nop 1
v_permlane32_swap_b32 v1, v2
v_add_f32 v1, v1, v2
v_mov_b32 v2, v1
s_nop 1
v_permlane16_swap_b32 v1, v2
v_add_f32 v1, v1, v2
s_mov_b64 exec, 0x101
ds_write2_b32 v7, v3, v1 offset0:0 offset1:8
s_mov_b64 exec, 1
ds_add_u32 v22, v23 offset:24
s_mov_b64 exec, -1
v_cvt_pk_bf16_f32 v2, v44, v44
v_and_b32 v180, v2, v108
v_and_b32 v181, v2, v109
v_and_b32 v182, v2, v110
v_and_b32 v183, v2, v111
v_cvt_pk_bf16_f32 v2, v45, v45
v_and_b32 v184, v2, v108
v_and_b32 v185, v2, v109
v_and_b32 v186, v2, v110
v_and_b32 v187, v2, v111
v_cvt_pk_bf16_f32 v2, v46, v46
v_and_b32 v188, v2, v108
v_and_b32 v189, v2, v109
v_and_b32 v190, v2, v110
v_and_b32 v191, v2, v111
v_cvt_pk_bf16_f32 v2, v47, v47
v_and_b32 v192, v2, v108
v_and_b32 v193, v2, v109
v_and_b32 v194, v2, v110
v_and_b32 v195, v2, v111
s_waitcnt vmcnt(5)
buffer_load_dwordx4 v[172:175], v16, s[12:15], s60 offen offset:2048 nt
v_cvt_pk_bf16_f32 v2, v48, v48
v_and_b32 v196, v2, v108
v_and_b32 v197, v2, v109
v_and_b32 v198, v2, v110
v_and_b32 v199, v2, v111
v_cvt_pk_bf16_f32 v2, v49, v49
v_and_b32 v200, v2, v108
v_and_b32 v201, v2, v109
v_and_b32 v202, v2, v110
v_and_b32 v203, v2, v111
v_cvt_pk_bf16_f32 v2, v50, v50
v_and_b32 v204, v2, v108
v_and_b32 v205, v2, v109
v_and_b32 v206, v2, v110
v_and_b32 v207, v2, v111
v_cvt_pk_bf16_f32 v2, v51, v51
v_and_b32 v208, v2, v108
v_and_b32 v209, v2, v109
v_and_b32 v210, v2, v110
v_and_b32 v211, v2, v111
v_mfma_f32_16x16x32_bf16 v[112:115], v[180:183], v[116:119], 0
v_mfma_f32_16x16x32_bf16 v[112:115], v[184:187], v[120:123], v[112:115]
v_mfma_f32_16x16x32_bf16 v[112:115], v[188:191], v[124:127], v[112:115]
v_mfma_f32_16x16x32_bf16 v[112:115], v[192:195], v[128:131], v[112:115]
s_waitcnt vmcnt(5)
buffer_load_dwordx4 v[176:179], v16, s[12:15], s60 offen offset:3072 nt
v_cvt_pk_bf16_f32 v2, v52, v52
v_and_b32 v212, v2, v108
v_and_b32 v213, v2, v109
v_and_b32 v214, v2, v110
v_and_b32 v215, v2, v111
v_cvt_pk_bf16_f32 v2, v53, v53
v_and_b32 v216, v2, v108
v_and_b32 v217, v2, v109
v_and_b32 v218, v2, v110
v_and_b32 v219, v2, v111
v_cvt_pk_bf16_f32 v2, v54, v54
v_and_b32 v220, v2, v108
v_and_b32 v221, v2, v109
v_and_b32 v222, v2, v110
v_and_b32 v223, v2, v111
v_cvt_pk_bf16_f32 v2, v55, v55
v_and_b32 v224, v2, v108
v_and_b32 v225, v2, v109
v_and_b32 v226, v2, v110
v_and_b32 v227, v2, v111
v_mfma_f32_16x16x32_bf16 v[112:115], v[196:199], v[132:135], v[112:115]
v_mfma_f32_16x16x32_bf16 v[112:115], v[200:203], v[136:139], v[112:115]
v_mfma_f32_16x16x32_bf16 v[112:115], v[204:207], v[140:143], v[112:115]
v_mfma_f32_16x16x32_bf16 v[112:115], v[208:211], v[144:147], v[112:115]
v_cvt_pk_bf16_f32 v2, v56, v56
v_and_b32 v228, v2, v108
v_and_b32 v229, v2, v109
v_and_b32 v230, v2, v110
v_and_b32 v231, v2, v111
v_cvt_pk_bf16_f32 v2, v57, v57
v_and_b32 v232, v2, v108
v_and_b32 v233, v2, v109
v_and_b32 v234, v2, v110
v_and_b32 v235, v2, v111
v_cvt_pk_bf16_f32 v2, v58, v58
v_and_b32 v236, v2, v108
v_and_b32 v237, v2, v109
v_and_b32 v238, v2, v110
v_and_b32 v239, v2, v111
v_cvt_pk_bf16_f32 v2, v59, v59
v_and_b32 v240, v2, v108
v_and_b32 v241, v2, v109
v_and_b32 v242, v2, v110
v_and_b32 v243, v2, v111
v_mfma_f32_16x16x32_bf16 v[112:115], v[212:215], v[148:151], v[112:115]
v_mfma_f32_16x16x32_bf16 v[112:115], v[216:219], v[152:155], v[112:115]
s_nop 0
s_cmp_ge_u32 s30, 9
s_cbranch_scc1 L_mp
s_lshl_b32 s56, s30, 7
s_add_u32 s50, s50, s56
s_lshl_b32 s31, s30, 5
s_add_u32 s31, s31, s44
s_lshl_b32 s31, s31, 10
s_add_u32 s31, s31, 479232
s_waitcnt vmcnt(5)
v_mfma_f32_16x16x32_bf16 v[112:115], v[220:223], v[156:159], v[112:115]
s_mov_b32 m0, s51
s_nop 0
buffer_load_dwordx4 v10, s[24:27], s50 offen nt lds
s_waitcnt vmcnt(5)
v_mfma_f32_16x16x32_bf16 v[112:115], v[224:227], v[160:163], v[112:115]
s_addk_i32 m0, 0x400
s_add_u32 s50, s50, 9216
buffer_load_dwordx4 v11, s[24:27], s50 offen nt lds
s_waitcnt vmcnt(5)
v_mfma_f32_16x16x32_bf16 v[112:115], v[228:231], v[164:167], v[112:115]
s_addk_i32 m0, 0x400
s_add_u32 s50, s50, 9216
buffer_load_dwordx4 v10, s[24:27], s50 offen nt lds
s_waitcnt vmcnt(5)
v_mfma_f32_16x16x32_bf16 v[112:115], v[232:235], v[168:171], v[112:115]
s_addk_i32 m0, 0x400
s_add_u32 s50, s50, 9216
buffer_load_dwordx4 v11, s[24:27], s50 offen nt lds
s_waitcnt vmcnt(5)
v_mfma_f32_16x16x32_bf16 v[112:115], v[236:239], v[172:175], v[112:115]
s_addk_i32 m0, 0x400
s_add_u32 s50, s50, 9216
buffer_load_dwordx4 v10, s[24:27], s50 offen nt lds
s_waitcnt vmcnt(5)
v_mfma_f32_16x16x32_bf16 v[112:115], v[240:243], v[176:179], v[112:115]
s_nop 7
ds_write_b128 v9, v[112:115]
s_mov_b64 exec, 1
ds_add_u32 v22, v23 offset:12
s_mov_b64 exec, -1
s_addk_i32 m0, 0x400
s_add_u32 s50, s50, 9216
buffer_load_dwordx4 v11, s[24:27], s50 offen nt lds
s_addk_i32 m0, 0x400
s_add_u32 s50, s50, 9216
buffer_load_dwordx4 v10, s[24:27], s50 offen nt lds
s_addk_i32 m0, 0x400
s_add_u32 s50, s50, 9216
buffer_load_dwordx4 v11, s[24:27], s50 offen nt lds
v_lshlrev_b32 v1, 4, v0
v_lshrrev_b32 v4, 4, v0
v_and_b32 v5, 15, v0
v_mul_u32_u24 v2, 576, v4
v_lshl_add_u32 v2, v5, 3, v2
v_add_u32 v2, s28, v2
v_mul_u32_u24 v3, 0x90, v5
v_lshl_add_u32 v3, v4, 4, v3
v_add_u32 v3, s28, v3
s_lshl_b32 s56, s3, 10
s_add_u32 s56, s56, 139264
v_add_u32 v8, s56, v1
v_add_u32 v9, 139264, v1
L_wpe:
ds_read_b32 v4, v22 offset:28
s_waitcnt lgkmcnt(0)
v_readfirstlane_b32 s4, v4
s_cmp_lt_u32 s4, 1
s_cbranch_scc1 L_wpe
buffer_load_dwordx4 v[116:119], v1, s[32:35], s54 offen offset:0 sc1
buffer_load_dwordx4 v[120:123], v1, s[32:35], s54 offen offset:1024 sc1
buffer_load_dwordx4 v[124:127], v1, s[32:35], s54 offen offset:2048 sc1
buffer_load_dwordx4 v[128:131], v1, s[32:35], s54 offen offset:3072 sc1
s_waitcnt vmcnt(8)
ds_read_b64_tr_b16 v[180:181], v17 offset:0
ds_read_b64_tr_b16 v[182:183], v17 offset:512
ds_read_b64_tr_b16 v[184:185], v18 offset:0
ds_read_b64_tr_b16 v[186:187], v18 offset:512
ds_read_b64_tr_b16 v[188:189], v19 offset:0
ds_read_b64_tr_b16 v[190:191], v19 offset:512
ds_read_b64_tr_b16 v[192:193], v20 offset:0
ds_read_b64_tr_b16 v[194:195], v20 offset:512
s_waitcnt vmcnt(4)
ds_read_b64_tr_b16 v[196:197], v17 offset:4096
ds_read_b64_tr_b16 v[198:199], v17 offset:4608
ds_read_b64_tr_b16 v[200:201], v18 offset:4096
ds_read_b64_tr_b16 v[202:203], v18 offset:4608
ds_read_b64_tr_b16 v[204:205], v19 offset:4096
ds_read_b64_tr_b16 v[206:207], v19 offset:4608
ds_read_b64_tr_b16 v[208:209], v20 offset:4096
ds_read_b64_tr_b16 v[210:211], v20 offset:4608
s_mov_b32 s59, 0
s_waitcnt vmcnt(3)
v_xor_b32 v118, v118, v21
v_cmp_lt_u32 s[8:9], 1, v118
s_waitcnt vmcnt(2)
v_xor_b32 v122, v122, v21
v_cmp_lt_u32 s[10:11], 1, v122
s_waitcnt vmcnt(1)
v_xor_b32 v126, v126, v21
v_cmp_lt_u32 s[12:13], 1, v126
s_waitcnt vmcnt(0)
v_xor_b32 v130, v130, v21
v_cmp_lt_u32 s[14:15], 1, v130
L_po:
s_or_b64 s[4:5], s[8:9], s[10:11]
s_or_b64 s[16:17], s[12:13], s[14:15]
s_or_b64 s[4:5], s[4:5], s[16:17]
s_cbranch_scc0 L_po_out
s_mov_b64 exec, s[8:9]
s_cbranch_execz L_po_s0
buffer_load_dwordx4 v[116:119], v1, s[32:35], s54 offen offset:0 sc1
L_po_s0:
s_mov_b64 exec, s[10:11]
s_cbranch_execz L_po_s1
buffer_load_dwordx4 v[120:123], v1, s[32:35], s54 offen offset:1024 sc1
L_po_s1:
s_mov_b64 exec, s[12:13]
s_cbranch_execz L_po_s2
buffer_load_dwordx4 v[124:127], v1, s[32:35], s54 offen offset:2048 sc1
L_po_s2:
s_mov_b64 exec, s[14:15]
s_cbranch_execz L_po_s3
buffer_load_dwordx4 v[128:131], v1, s[32:35], s54 offen offset:3072 sc1
L_po_s3:
s_add_u32 s59, s59, 1
s_cmp_gt_u32 s59, 100000
s_waitcnt vmcnt(0)
s_cbranch_scc1 L_po_out
s_mov_b64 exec, s[8:9]
v_xor_b32 v118, v118, v21
v_cmp_lt_u32 s[8:9], 1, v118
s_mov_b64 exec, s[10:11]
v_xor_b32 v122, v122, v21
v_cmp_lt_u32 s[10:11], 1, v122
s_mov_b64 exec, s[12:13]
v_xor_b32 v126, v126, v21
v_cmp_lt_u32 s[12:13], 1, v126
s_mov_b64 exec, s[14:15]
v_xor_b32 v130, v130, v21
v_cmp_lt_u32 s[14:15], 1, v130
s_branch L_po
L_po_out:
s_mov_b64 exec, -1
ds_write_b64 v2, v[116:117] offset:0
ds_write_b64 v2, v[120:121] offset:144
ds_write_b64 v2, v[124:125] offset:288
ds_write_b64 v2, v[128:129] offset:432
ds_read_b128 v[92:95], v3
ds_read_b128 v[96:99], v3 offset:64
v_max3_f32 v6, v119, v123, v127
v_max_f32 v6, v6, v131
v_sub_f32 v24, v119, v6
v_sub_f32 v25, v123, v6
v_sub_f32 v26, v127, v6
v_sub_f32 v27, v131, v6
v_exp_f32 v24, v24
v_exp_f32 v25, v25
v_exp_f32 v26, v26
v_exp_f32 v27, v27
v_or3_b32 v5, v118, v122, v126
v_add_f32 v6, v24, v25
v_add_f32 v7, v26, v27
v_add_f32 v6, v6, v7
v_rcp_f32 v6, v6
v_or_b32 v5, v5, v130
v_mul_f32 v6, v6, v42
s_waitcnt lgkmcnt(1)
v_mfma_f32_16x16x32_bf16 v[44:47], v[92:95], v[180:183], 0
v_mfma_f32_16x16x32_bf16 v[48:51], v[92:95], v[184:187], 0
v_mfma_f32_16x16x32_bf16 v[52:55], v[92:95], v[188:191], 0
v_mfma_f32_16x16x32_bf16 v[56:59], v[92:95], v[192:195], 0
v_pk_mul_f32 v[24:25], v[24:25], v[6:7] op_sel:[0,0] op_sel_hi:[1,0]
v_pk_mul_f32 v[26:27], v[26:27], v[6:7] op_sel:[0,0] op_sel_hi:[1,0]
v_cmp_ne_u32 vcc, 0, v5
s_waitcnt lgkmcnt(0)
v_mfma_f32_16x16x32_bf16 v[44:47], v[96:99], v[196:199], v[44:47]
v_mfma_f32_16x16x32_bf16 v[48:51], v[96:99], v[200:203], v[48:51]
v_mfma_f32_16x16x32_bf16 v[52:55], v[96:99], v[204:207], v[52:55]
v_mfma_f32_16x16x32_bf16 v[56:59], v[96:99], v[208:211], v[56:59]
s_nop 4
v_pk_mul_f32 v[44:45], v[44:45], v[24:25]
v_pk_mul_f32 v[48:49], v[48:49], v[24:25]
v_pk_mul_f32 v[52:53], v[52:53], v[24:25]
v_pk_mul_f32 v[56:57], v[56:57], v[24:25]
v_pk_fma_f32 v[44:45], v[46:47], v[26:27], v[44:45]
v_pk_fma_f32 v[48:49], v[50:51], v[26:27], v[48:49]
v_pk_fma_f32 v[52:53], v[54:55], v[26:27], v[52:53]
v_pk_fma_f32 v[56:57], v[58:59], v[26:27], v[56:57]
v_add_f32 v28, v44, v45
v_add_f32 v29, v48, v49
v_add_f32 v30, v52, v53
v_add_f32 v31, v56, v57
ds_write_b128 v8, v[28:31]
s_mov_b64 exec, 1
ds_add_rtn_u32 v4, v22, v23 offset:32
s_mov_b64 exec, -1
ds_read_b128 v[116:119], v9 offset:0
ds_read_b128 v[120:123], v9 offset:1024
ds_read_b128 v[124:127], v9 offset:2048
ds_read_b128 v[128:131], v9 offset:3072
s_waitcnt lgkmcnt(4)
v_readfirstlane_b32 s4, v4
s_cmp_lg_u32 s4, 3
s_cbranch_scc1 L_fin
s_waitcnt lgkmcnt(2)
v_pk_add_f32 v[116:117], v[116:117], v[120:121]
v_pk_add_f32 v[118:119], v[118:119], v[122:123]
s_waitcnt lgkmcnt(0)
v_pk_add_f32 v[124:125], v[124:125], v[128:129]
v_pk_add_f32 v[126:127], v[126:127], v[130:131]
v_pk_add_f32 v[116:117], v[116:117], v[124:125]
v_pk_add_f32 v[118:119], v[118:119], v[126:127]
v_perm_b32 v4, v116, v21, s97
v_perm_b32 v5, v117, v21, s98
v_perm_b32 v6, v118, v21, s99
v_perm_b32 v7, v119, v21, s100
buffer_store_dwordx4 v[4:7], v1, s[32:35], s31 offen sc1
s_cbranch_vccz L_fin
s_cmp_lg_u32 s45, 0
s_cbranch_scc1 L_fin
buffer_wbl2 sc1
s_waitcnt vmcnt(0)
s_endpgm
L_mp:
s_waitcnt vmcnt(5)
v_mfma_f32_16x16x32_bf16 v[112:115], v[220:223], v[156:159], v[112:115]
s_waitcnt vmcnt(4)
v_mfma_f32_16x16x32_bf16 v[112:115], v[224:227], v[160:163], v[112:115]
s_waitcnt vmcnt(3)
v_mfma_f32_16x16x32_bf16 v[112:115], v[228:231], v[164:167], v[112:115]
s_waitcnt vmcnt(2)
v_mfma_f32_16x16x32_bf16 v[112:115], v[232:235], v[168:171], v[112:115]
s_waitcnt vmcnt(1)
v_mfma_f32_16x16x32_bf16 v[112:115], v[236:239], v[172:175], v[112:115]
s_waitcnt vmcnt(0)
v_mfma_f32_16x16x32_bf16 v[112:115], v[240:243], v[176:179], v[112:115]
s_nop 7
ds_write_b128 v9, v[112:115]
s_mov_b64 exec, 1
ds_add_u32 v22, v23 offset:12
s_endpgm
.p2align 6
L_mn:
s_load_dwordx2 s[8:9], s[0:1], 8
s_lshr_b32 s56, s45, 2
s_lshl4_add_u32 s52, s56, s44
s_lshl_b32 s52, s52, 20
s_and_b32 s56, s45, 3
s_lshl2_add_u32 s56, s56, s3
s_add_u32 s56, s56, 48
s_lshl_b32 s56, s56, 14
s_add_u32 s52, s52, s56
s_lshr_b32 s56, s46, 2
s_add_u32 s56, s56, s46
s_add_u32 s57, s56, 0
s_and_b32 s57, s57, 3
s_lshl_b32 s57, s57, 12
s_add_u32 s40, s52, s57
s_add_u32 s57, s56, 1
s_and_b32 s57, s57, 3
s_lshl_b32 s57, s57, 12
s_add_u32 s41, s52, s57
s_add_u32 s57, s56, 2
s_and_b32 s57, s57, 3
s_lshl_b32 s57, s57, 12
s_add_u32 s42, s52, s57
s_add_u32 s57, s56, 3
s_and_b32 s57, s57, 3
s_lshl_b32 s57, s57, 12
s_add_u32 s43, s52, s57
s_lshl_b32 s28, s3, 14
s_add_u32 s28, s28, 73728
s_mov_b32 s10, 67108864
s_mov_b32 s11, 0x20000
v_lshrrev_b32 v4, 4, v0
v_and_b32 v5, 15, v0
v_lshlrev_b32 v6, 2, v4
v_xor_b32 v6, v6, v5
v_lshlrev_b32 v6, 4, v6
v_lshl_add_u32 v12, v4, 8, v6
v_xor_b32 v13, 16, v12
v_xor_b32 v14, 32, v12
v_xor_b32 v15, 48, v12
s_waitcnt lgkmcnt(0)
s_add_u32 m0, s28, 0
s_mov_b32 s29, s40
buffer_load_dwordx4 v12, s[8:11], s29 offen nt lds
buffer_load_dwordx4 v13, s[8:11], s29 offen offset:1024 nt lds
buffer_load_dwordx4 v14, s[8:11], s29 offen offset:2048 nt lds
buffer_load_dwordx4 v15, s[8:11], s29 offen offset:3072 nt lds
s_add_u32 m0, s28, 4096
s_mov_b32 s29, s41
buffer_load_dwordx4 v12, s[8:11], s29 offen nt lds
s_load_dwordx2 s[12:13], s[0:1], 16
s_mov_b32 s14, 67108864
s_mov_b32 s15, 0x20000
v_lshlrev_b32 v16, 4, v0
v_mov_b32 v22, 148640
v_mov_b32 v23, 1
s_waitcnt lgkmcnt(0)
s_barrier
s_waitcnt vmcnt(4)
buffer_load_dwordx4 v13, s[8:11], s29 offen offset:1024 nt lds
s_waitcnt vmcnt(4)
buffer_load_dwordx4 v14, s[8:11], s29 offen offset:2048 nt lds
s_waitcnt vmcnt(4)
buffer_load_dwordx4 v15, s[8:11], s29 offen offset:3072 nt lds
s_waitcnt vmcnt(4)
s_add_u32 m0, s28, 8192
s_mov_b32 s29, s42
buffer_load_dwordx4 v12, s[8:11], s29 offen nt lds
s_waitcnt vmcnt(4)
buffer_load_dwordx4 v13, s[8:11], s29 offen offset:1024 nt lds
s_waitcnt vmcnt(4)
buffer_load_dwordx4 v14, s[8:11], s29 offen offset:2048 nt lds
s_waitcnt vmcnt(4)
buffer_load_dwordx4 v15, s[8:11], s29 offen offset:3072 nt lds
s_waitcnt vmcnt(4)
s_add_u32 m0, s28, 12288
s_mov_b32 s29, s43
buffer_load_dwordx4 v12, s[8:11], s29 offen nt lds
s_waitcnt vmcnt(4)
buffer_load_dwordx4 v13, s[8:11], s29 offen offset:1024 nt lds
s_waitcnt vmcnt(4)
buffer_load_dwordx4 v14, s[8:11], s29 offen offset:2048 nt lds
s_waitcnt vmcnt(4)
buffer_load_dwordx4 v15, s[8:11], s29 offen offset:3072 nt lds
s_waitcnt vmcnt(4)
s_mov_b32 s60, s40
buffer_load_dwordx4 v[116:119], v16, s[12:15], s60 offen nt
v_and_b32 v5, 15, v0
v_lshrrev_b32 v4, 4, v0
v_xor_b32 v6, v4, v5
v_lshlrev_b32 v6, 4, v6
v_and_b32 v7, 3, v5
v_lshl_add_u32 v6, v7, 10, v6
v_lshrrev_b32 v7, 2, v5
v_lshl_add_u32 v6, v7, 8, v6
v_add_u32 v12, s28, v6
v_xor_b32 v13, 64, v12
v_xor_b32 v14, 0x80, v12
v_xor_b32 v15, 0xc0, v12
v_lshrrev_b32 v7, 3, v5
v_lshlrev_b32 v8, 8, v7
v_lshl_add_u32 v8, v4, 4, v8
v_add_u32 v8, 147456, v8
s_lshl_b32 s56, s3, 2
s_add_u32 s56, s56, 148544
v_lshl_add_u32 v7, v7, 4, s56
v_lshrrev_b32 v6, 1, v4
v_and_b32 v4, 1, v4
v_lshlrev_b32 v6, 9, v6
v_lshl_add_u32 v6, v5, 5, v6
v_lshl_add_u32 v6, v4, 4, v6
s_lshl_b32 s56, s3, 10
s_add_u32 s56, s56, 143360
v_add_u32 v9, s56, v6
v_and_b32 v1, 1, v0
v_lshlrev_b32 v1, 4, v1
v_mov_b32 v2, 0xffff
v_lshlrev_b32 v1, v1, v2
v_bfe_u32 v2, v0, 1, 2
v_cmp_eq_u32 s[4:5], 0, v2
s_nop 1
v_cndmask_b32 v108, 0, v1, s[4:5]
v_cmp_eq_u32 s[4:5], 1, v2
s_nop 1
v_cndmask_b32 v109, 0, v1, s[4:5]
v_cmp_eq_u32 s[4:5], 2, v2
s_nop 1
v_cndmask_b32 v110, 0, v1, s[4:5]
v_cmp_eq_u32 s[4:5], 3, v2
s_nop 1
v_cndmask_b32 v111, 0, v1, s[4:5]
s_waitcnt vmcnt(4)
buffer_load_dwordx4 v[120:123], v16, s[12:15], s60 offen offset:1024 nt
s_waitcnt vmcnt(4)
buffer_load_dwordx4 v[124:127], v16, s[12:15], s60 offen offset:2048 nt
s_waitcnt vmcnt(4)
buffer_load_dwordx4 v[128:131], v16, s[12:15], s60 offen offset:3072 nt
s_waitcnt vmcnt(4)
s_mov_b32 s60, s41
buffer_load_dwordx4 v[132:135], v16, s[12:15], s60 offen nt
s_waitcnt vmcnt(4)
buffer_load_dwordx4 v[136:139], v16, s[12:15], s60 offen offset:1024 nt
s_waitcnt vmcnt(4)
buffer_load_dwordx4 v[140:143], v16, s[12:15], s60 offen offset:2048 nt
s_waitcnt vmcnt(4)
buffer_load_dwordx4 v[144:147], v16, s[12:15], s60 offen offset:3072 nt
s_waitcnt vmcnt(4)
s_mov_b32 s60, s42
buffer_load_dwordx4 v[148:151], v16, s[12:15], s60 offen nt
s_waitcnt vmcnt(4)
buffer_load_dwordx4 v[152:155], v16, s[12:15], s60 offen offset:1024 nt
s_waitcnt vmcnt(4)
buffer_load_dwordx4 v[156:159], v16, s[12:15], s60 offen offset:2048 nt
s_waitcnt vmcnt(4)
buffer_load_dwordx4 v[160:163], v16, s[12:15], s60 offen offset:3072 nt
s_waitcnt vmcnt(4)
s_mov_b32 s60, s43
buffer_load_dwordx4 v[164:167], v16, s[12:15], s60 offen nt
s_waitcnt vmcnt(4)
buffer_load_dwordx4 v[168:171], v16, s[12:15], s60 offen offset:1024 nt
s_waitcnt vmcnt(4)
buffer_load_dwordx4 v[172:175], v16, s[12:15], s60 offen offset:2048 nt
s_waitcnt vmcnt(4)
buffer_load_dwordx4 v[176:179], v16, s[12:15], s60 offen offset:3072 nt
s_mov_b64 exec, 1
ds_add_u32 v22, v23 offset:4
s_mov_b64 exec, -1
ds_read_b128 v[60:63], v12 offset:0
ds_read_b128 v[64:67], v13 offset:0
ds_read_b128 v[68:71], v14 offset:0
ds_read_b128 v[72:75], v15 offset:0
ds_read_b128 v[76:79], v12 offset:4096
ds_read_b128 v[80:83], v13 offset:4096
ds_read_b128 v[84:87], v14 offset:4096
ds_read_b128 v[88:91], v15 offset:4096
L_wqn:
ds_read_b32 v1, v22 offset:8
ds_read_b128 v[92:95], v8 offset:0
ds_read_b128 v[96:99], v8 offset:64
ds_read_b128 v[100:103], v8 offset:128
ds_read_b128 v[104:107], v8 offset:192
s_waitcnt lgkmcnt(4)
v_readfirstlane_b32 s4, v1
s_cmp_lt_u32 s4, 1
s_cbranch_scc1 L_wqn
s_mov_b32 s56, 0x3e0293ee
s_waitcnt lgkmcnt(0)
v_mfma_f32_16x16x32_bf16 v[44:47], v[60:63], v[92:95], 0
v_mfma_f32_16x16x32_bf16 v[44:47], v[64:67], v[96:99], v[44:47]
v_mfma_f32_16x16x32_bf16 v[44:47], v[68:71], v[100:103], v[44:47]
v_mfma_f32_16x16x32_bf16 v[44:47], v[72:75], v[104:107], v[44:47]
ds_read_b128 v[60:63], v12 offset:8192
ds_read_b128 v[64:67], v13 offset:8192
ds_read_b128 v[68:71], v14 offset:8192
ds_read_b128 v[72:75], v15 offset:8192
v_mfma_f32_16x16x32_bf16 v[48:51], v[76:79], v[92:95], 0
v_mfma_f32_16x16x32_bf16 v[48:51], v[80:83], v[96:99], v[48:51]
v_mfma_f32_16x16x32_bf16 v[48:51], v[84:87], v[100:103], v[48:51]
v_mfma_f32_16x16x32_bf16 v[48:51], v[88:91], v[104:107], v[48:51]
ds_read_b128 v[76:79], v12 offset:12288
ds_read_b128 v[80:83], v13 offset:12288
ds_read_b128 v[84:87], v14 offset:12288
ds_read_b128 v[88:91], v15 offset:12288
s_waitcnt lgkmcnt(4)
v_mfma_f32_16x16x32_bf16 v[52:55], v[60:63], v[92:95], 0
v_mfma_f32_16x16x32_bf16 v[52:55], v[64:67], v[96:99], v[52:55]
v_mfma_f32_16x16x32_bf16 v[52:55], v[68:71], v[100:103], v[52:55]
v_mfma_f32_16x16x32_bf16 v[52:55], v[72:75], v[104:107], v[52:55]
s_waitcnt lgkmcnt(0)
v_mfma_f32_16x16x32_bf16 v[56:59], v[76:79], v[92:95], 0
v_mfma_f32_16x16x32_bf16 v[56:59], v[80:83], v[96:99], v[56:59]
v_mfma_f32_16x16x32_bf16 v[56:59], v[84:87], v[100:103], v[56:59]
v_mfma_f32_16x16x32_bf16 v[56:59], v[88:91], v[104:107], v[56:59]
v_max3_f32 v1, v44, v45, v46
v_max3_f32 v1, v1, v47, v48
v_max3_f32 v1, v1, v49, v50
v_max_f32 v1, v1, v51
v_max3_f32 v2, v52, v53, v54
v_max_f32 v2, v2, v55
s_nop 2
v_max3_f32 v1, v1, v56, v57
v_max3_f32 v2, v2, v58, v59
v_max_f32 v1, v1, v2
v_mov_b32 v2, v1
s_nop 1
v_permlane32_swap_b32 v1, v2
v_max_f32 v1, v1, v2
v_mov_b32 v2, v1
s_nop 1
v_permlane16_swap_b32 v1, v2
v_max_f32 v1, v1, v2
v_mul_f32 v3, s56, v1
v_fma_f32 v44, v44, s56, -v3
v_fma_f32 v45, v45, s56, -v3
v_fma_f32 v46, v46, s56, -v3
v_fma_f32 v47, v47, s56, -v3
v_fma_f32 v48, v48, s56, -v3
v_fma_f32 v49, v49, s56, -v3
v_fma_f32 v50, v50, s56, -v3
v_fma_f32 v51, v51, s56, -v3
v_fma_f32 v52, v52, s56, -v3
v_fma_f32 v53, v53, s56, -v3
v_fma_f32 v54, v54, s56, -v3
v_fma_f32 v55, v55, s56, -v3
v_fma_f32 v56, v56, s56, -v3
v_fma_f32 v57, v57, s56, -v3
v_fma_f32 v58, v58, s56, -v3
v_fma_f32 v59, v59, s56, -v3
v_exp_f32 v44, v44
v_exp_f32 v45, v45
v_exp_f32 v46, v46
v_exp_f32 v47, v47
v_exp_f32 v48, v48
v_exp_f32 v49, v49
v_exp_f32 v50, v50
v_exp_f32 v51, v51
v_exp_f32 v52, v52
v_exp_f32 v53, v53
v_exp_f32 v54, v54
v_exp_f32 v55, v55
v_exp_f32 v56, v56
v_exp_f32 v57, v57
v_exp_f32 v58, v58
v_exp_f32 v59, v59
v_add_f32 v1, v44, v45
v_add_f32 v2, v46, v47
v_add_f32 v1, v1, v48
v_add_f32 v2, v2, v49
v_add_f32 v1, v1, v50
v_add_f32 v2, v2, v51
v_add_f32 v1, v1, v52
v_add_f32 v2, v2, v53
v_add_f32 v1, v1, v54
v_add_f32 v2, v2, v55
v_add_f32 v1, v1, v56
v_add_f32 v2, v2, v57
v_add_f32 v1, v1, v58
v_add_f32 v2, v2, v59
v_add_f32 v1, v1, v2
v_mov_b32 v2, v1
s_nop 1
v_permlane32_swap_b32 v1, v2
v_add_f32 v1, v1, v2
v_mov_b32 v2, v1
s_nop 1
v_permlane16_swap_b32 v1, v2
v_add_f32 v1, v1, v2
s_mov_b64 exec, 0x101
ds_write2_b32 v7, v3, v1 offset0:0 offset1:8
s_mov_b64 exec, 1
ds_add_u32 v22, v23 offset:24
s_mov_b64 exec, -1
v_cvt_pk_bf16_f32 v2, v44, v44
v_and_b32 v180, v2, v108
v_and_b32 v181, v2, v109
v_and_b32 v182, v2, v110
v_and_b32 v183, v2, v111
v_cvt_pk_bf16_f32 v2, v45, v45
v_and_b32 v184, v2, v108
v_and_b32 v185, v2, v109
v_and_b32 v186, v2, v110
v_and_b32 v187, v2, v111
v_cvt_pk_bf16_f32 v2, v46, v46
v_and_b32 v188, v2, v108
v_and_b32 v189, v2, v109
v_and_b32 v190, v2, v110
v_and_b32 v191, v2, v111
v_cvt_pk_bf16_f32 v2, v47, v47
v_and_b32 v192, v2, v108
v_and_b32 v193, v2, v109
v_and_b32 v194, v2, v110
v_and_b32 v195, v2, v111
v_cvt_pk_bf16_f32 v2, v48, v48
v_and_b32 v196, v2, v108
v_and_b32 v197, v2, v109
v_and_b32 v198, v2, v110
v_and_b32 v199, v2, v111
v_cvt_pk_bf16_f32 v2, v49, v49
v_and_b32 v200, v2, v108
v_and_b32 v201, v2, v109
v_and_b32 v202, v2, v110
v_and_b32 v203, v2, v111
v_cvt_pk_bf16_f32 v2, v50, v50
v_and_b32 v204, v2, v108
v_and_b32 v205, v2, v109
v_and_b32 v206, v2, v110
v_and_b32 v207, v2, v111
v_cvt_pk_bf16_f32 v2, v51, v51
v_and_b32 v208, v2, v108
v_and_b32 v209, v2, v109
v_and_b32 v210, v2, v110
v_and_b32 v211, v2, v111
v_mfma_f32_16x16x32_bf16 v[112:115], v[180:183], v[116:119], 0
v_mfma_f32_16x16x32_bf16 v[112:115], v[184:187], v[120:123], v[112:115]
v_mfma_f32_16x16x32_bf16 v[112:115], v[188:191], v[124:127], v[112:115]
v_mfma_f32_16x16x32_bf16 v[112:115], v[192:195], v[128:131], v[112:115]
v_cvt_pk_bf16_f32 v2, v52, v52
v_and_b32 v212, v2, v108
v_and_b32 v213, v2, v109
v_and_b32 v214, v2, v110
v_and_b32 v215, v2, v111
v_cvt_pk_bf16_f32 v2, v53, v53
v_and_b32 v216, v2, v108
v_and_b32 v217, v2, v109
v_and_b32 v218, v2, v110
v_and_b32 v219, v2, v111
v_cvt_pk_bf16_f32 v2, v54, v54
v_and_b32 v220, v2, v108
v_and_b32 v221, v2, v109
v_and_b32 v222, v2, v110
v_and_b32 v223, v2, v111
v_cvt_pk_bf16_f32 v2, v55, v55
v_and_b32 v224, v2, v108
v_and_b32 v225, v2, v109
v_and_b32 v226, v2, v110
v_and_b32 v227, v2, v111
v_mfma_f32_16x16x32_bf16 v[112:115], v[196:199], v[132:135], v[112:115]
v_mfma_f32_16x16x32_bf16 v[112:115], v[200:203], v[136:139], v[112:115]
v_mfma_f32_16x16x32_bf16 v[112:115], v[204:207], v[140:143], v[112:115]
v_mfma_f32_16x16x32_bf16 v[112:115], v[208:211], v[144:147], v[112:115]
v_cvt_pk_bf16_f32 v2, v56, v56
v_and_b32 v228, v2, v108
v_and_b32 v229, v2, v109
v_and_b32 v230, v2, v110
v_and_b32 v231, v2, v111
v_cvt_pk_bf16_f32 v2, v57, v57
v_and_b32 v232, v2, v108
v_and_b32 v233, v2, v109
v_and_b32 v234, v2, v110
v_and_b32 v235, v2, v111
v_cvt_pk_bf16_f32 v2, v58, v58
v_and_b32 v236, v2, v108
v_and_b32 v237, v2, v109
v_and_b32 v238, v2, v110
v_and_b32 v239, v2, v111
v_cvt_pk_bf16_f32 v2, v59, v59
v_and_b32 v240, v2, v108
v_and_b32 v241, v2, v109
v_and_b32 v242, v2, v110
v_and_b32 v243, v2, v111
v_mfma_f32_16x16x32_bf16 v[112:115], v[212:215], v[148:151], v[112:115]
v_mfma_f32_16x16x32_bf16 v[112:115], v[216:219], v[152:155], v[112:115]
v_mfma_f32_16x16x32_bf16 v[112:115], v[220:223], v[156:159], v[112:115]
s_nop 0
s_waitcnt vmcnt(4)
v_mfma_f32_16x16x32_bf16 v[112:115], v[224:227], v[160:163], v[112:115]
s_waitcnt vmcnt(3)
v_mfma_f32_16x16x32_bf16 v[112:115], v[228:231], v[164:167], v[112:115]
s_waitcnt vmcnt(2)
v_mfma_f32_16x16x32_bf16 v[112:115], v[232:235], v[168:171], v[112:115]
s_waitcnt vmcnt(1)
v_mfma_f32_16x16x32_bf16 v[112:115], v[236:239], v[172:175], v[112:115]
s_waitcnt vmcnt(0)
v_mfma_f32_16x16x32_bf16 v[112:115], v[240:243], v[176:179], v[112:115]
s_nop 7
ds_write_b128 v9, v[112:115]
s_mov_b64 exec, 1
ds_add_u32 v22, v23 offset:12
s_endpgm
.p2align 6
L_t:
s_getpc_b64 s[4:5]
L_pc:
s_sub_u32 s4, s4, L_pc-gated_mix__sliding_block_cached__glu_gated_reglu__decode_kernel
s_subb_u32 s5, s5, 0
v_subrev_u32 v1, 0x100, v0
s_and_b32 s56, s46, 7
v_mad_u32_u24 v1, v1, 8, s56
v_lshlrev_b32 v1, 7, v1
v_cmp_gt_u32 vcc, L_code_end-gated_mix__sliding_block_cached__glu_gated_reglu__decode_kernel, v1
s_and_b64 exec, vcc, -1
s_cbranch_execz L_nopf
global_load_dword v43, v1, s[4:5]
L_nopf:
s_mov_b64 exec, -1
s_barrier
s_load_dwordx2 s[32:33], s[0:1], 96
v_and_b32 v0, 63, v0
s_mov_b32 s34, 1036288
s_mov_b32 s35, 0x20000
v_mov_b32 v22, 148640
v_mov_b32 v23, 1
s_sub_u32 s61, s3, 4
v_mov_b32 v21, 148000
s_cmp_ge_u32 s45, 13
s_cbranch_scc1 L_tn
s_load_dwordx2 s[36:37], s[0:1], 80
s_lshr_b32 s56, 0x8080, s47
s_and_b32 s56, s56, 0x1ff0
s_cmp_eq_u32 s49, 0
s_cselect_b32 s57, 8, 0
s_or_b32 s56, s56, s57
s_bfm_b32 s57, s45, 0
s_andn2_b32 s57, s57, s56
s_bcnt1_i32_b32 s30, s57
s_min_u32 s57, s30, 9
s_sub_u32 s60, s45, s57
s_bitcmp1_b32 s56, s45
s_cselect_b32 s30, 9, s30
s_cmp_lt_u32 s30, 9
s_cbranch_scc1 L_fin
s_cmp_gt_u32 s60, 2
s_cbranch_scc1 L_fin
s_mov_b32 s38, 4608
s_mov_b32 s39, 0x20000
s_mul_i32 s56, s44, 3
s_add_u32 s56, s56, s60
s_mul_i32 s56, s56, 3
s_add_u32 s56, s56, s61
s_lshr_b32 s55, s56, 4
s_and_b32 s54, s56, 15
s_lshl_b32 s57, s55, 15
s_lshl_b32 s50, s54, 6
s_add_u32 s57, s57, s50
s_add_u32 s97, s57, 479232
s_add_u32 s98, s97, 16384
v_lshrrev_b32 v1, 2, v0
v_and_b32 v2, 3, v0
v_lshlrev_b32 v8, 10, v1
v_lshl_add_u32 v8, v2, 4, v8
v_lshlrev_b32 v9, 5, v1
v_lshl_add_u32 v9, v2, 1, v9
s_lshr_b32 s50, s54, 2
s_mulk_i32 s50, 0x480
s_and_b32 s51, s54, 3
s_lshl3_add_u32 s50, s51, s50
s_lshl_b32 s51, s55, 7
s_add_u32 s50, s50, s51
s_mov_b32 s62, 0x0c0c0400
s_mov_b32 s63, 0x04000c0c
s_movk_i32 s51, 0xff00
s_waitcnt vmcnt(0) lgkmcnt(0)
s_barrier
ds_read_b32 v21, v21
s_waitcnt lgkmcnt(0)
s_mov_b32 s59, 0
L_pr:
buffer_load_dwordx4 v[24:27], v8, s[32:35], s97 offen sc1
buffer_load_dwordx4 v[28:31], v8, s[32:35], s98 offen sc1
s_waitcnt vmcnt(1)
v_perm_b32 v12, v25, v24, s62
v_perm_b32 v17, v27, v26, s63
v_or_b32 v12, v12, v17
v_xor_b32 v12, v12, v21
s_waitcnt vmcnt(0)
v_perm_b32 v13, v29, v28, s62
v_perm_b32 v17, v31, v30, s63
v_or_b32 v13, v13, v17
v_xor_b32 v13, v13, v21
v_or_b32 v12, v12, v13
v_cmp_ne_u32 vcc, 0, v12
s_add_u32 s59, s59, 1
s_cmp_gt_u32 s59, 100000
s_cbranch_scc1 L_pr_out
s_cbranch_vccnz L_pr
L_pr_out:
v_and_b32 v24, s51, v24
v_and_b32 v25, s51, v25
v_and_b32 v26, s51, v26
v_and_b32 v27, s51, v27
v_and_b32 v28, s51, v28
v_and_b32 v29, s51, v29
v_and_b32 v30, s51, v30
v_and_b32 v31, s51, v31
v_pk_add_f32 v[24:25], v[24:25], v[28:29]
v_pk_add_f32 v[26:27], v[26:27], v[30:31]
s_nop 0
v_add_f32_dpp v12, v24, v24 row_ror:8 row_mask:0xf bank_mask:0x3
v_add_f32_dpp v13, v25, v25 row_ror:8 row_mask:0xf bank_mask:0x3
s_nop 0
v_add_f32_dpp v12, v26, v26 row_ror:8 row_mask:0xf bank_mask:0xc
v_add_f32_dpp v13, v27, v27 row_ror:8 row_mask:0xf bank_mask:0xc
s_nop 0
v_add_f32_dpp v14, v12, v12 row_shl:4 row_mask:0xf bank_mask:0x5
s_nop 1
v_add_f32_dpp v14, v13, v13 row_shr:4 row_mask:0xf bank_mask:0xa
v_mov_b32 v15, v14
s_nop 1
v_permlane16_swap_b32 v14, v15
v_add_f32 v14, v14, v15
v_mov_b32 v15, v14
s_nop 1
v_permlane32_swap_b32 v14, v15
v_add_f32 v14, v14, v15
v_cvt_pk_bf16_f32 v14, v14, v14
s_mov_b64 exec, 0xffff
buffer_store_short v14, v9, s[36:39], s50 offen
s_cmp_lg_u32 s56, 0
s_cbranch_scc1 L_fin
s_mov_b64 exec, 1
v_mov_b32 v1, 0
buffer_store_dword v21, v1, s[32:35], 0 offen offset:0
s_endpgm
L_tn:
s_load_dwordx2 s[24:25], s[0:1], 64
s_mov_b32 s26, 5308416
s_mov_b32 s27, 0x20000
s_movk_i32 s56, 0x480
v_lshrrev_b32 v1, 3, v0
v_and_b32 v2, 2, v1
v_and_b32 v3, 7, v0
v_xor_b32 v2, v2, v3
v_lshlrev_b32 v2, 4, v2
v_mad_u32_u24 v10, v1, s56, v2
v_xor_b32 v11, 64, v10
s_mul_i32 s51, s61, 24576
v_lshrrev_b32 v4, 4, v0
v_bfe_u32 v5, v0, 2, 2
v_and_b32 v6, 3, v0
v_lshl_add_u32 v7, v4, 3, v5
v_lshlrev_b32 v7, 7, v7
v_lshl_add_u32 v7, v6, 3, v7
v_add_u32 v7, s51, v7
v_and_b32 v8, 1, v4
v_lshrrev_b32 v9, 1, v5
v_lshl_add_u32 v8, v8, 1, v9
v_lshl_add_u32 v17, v8, 5, v7
v_xor_b32 v18, 32, v17
v_xor_b32 v19, 64, v17
v_xor_b32 v20, 0x60, v17
s_mov_b32 s96, 0x7060500
s_mov_b32 s97, 0x7060501
s_mov_b32 s98, 0x7060502
s_mov_b32 s99, 0x7060503
v_lshlrev_b32 v8, 4, v0
v_bfe_u32 v1, v0, 2, 2
v_lshrrev_b32 v4, 4, v0
s_mov_b32 m0, s51
s_waitcnt vmcnt(0) lgkmcnt(0)
s_sub_u32 s56, s45, 13
s_mul_i32 s55, s56, 3
s_add_u32 s55, s55, s61
s_lshl1_add_u32 s50, s47, s49
s_mul_i32 s50, s50, 331776
s_lshl_b32 s56, s55, 7
s_add_u32 s50, s50, s56
s_lshl_b32 s57, s55, 5
s_add_u32 s57, s57, s44
s_lshl_b32 s57, s57, 10
s_add_u32 s57, s57, 495616
v_mul_u32_u24 v2, 656, v1
v_lshl_add_u32 v9, v4, 4, v2
s_lshl_b32 s56, s49, 6
s_add_u32 s56, s56, 148736
v_add_u32 v9, s56, v9
v_lshlrev_b32 v3, 2, v4
v_add_u32 v3, 147984, v3
L_wvn:
ds_read_b32 v1, v22 offset:4
s_waitcnt lgkmcnt(0)
v_readfirstlane_b32 s4, v1
s_cmp_lt_u32 s4, 4
s_cbranch_scc1 L_wvn
buffer_load_dwordx4 v10, s[24:27], s50 offen nt lds
s_add_u32 m0, m0, 1024
s_add_u32 s50, s50, 9216
buffer_load_dwordx4 v11, s[24:27], s50 offen nt lds
s_add_u32 m0, m0, 1024
s_add_u32 s50, s50, 9216
buffer_load_dwordx4 v10, s[24:27], s50 offen nt lds
s_add_u32 m0, m0, 1024
s_add_u32 s50, s50, 9216
buffer_load_dwordx4 v11, s[24:27], s50 offen nt lds
s_add_u32 m0, m0, 1024
s_add_u32 s50, s50, 9216
buffer_load_dwordx4 v10, s[24:27], s50 offen nt lds
s_add_u32 m0, m0, 1024
s_add_u32 s50, s50, 9216
buffer_load_dwordx4 v11, s[24:27], s50 offen nt lds
s_add_u32 m0, m0, 1024
s_add_u32 s50, s50, 9216
buffer_load_dwordx4 v10, s[24:27], s50 offen nt lds
s_add_u32 m0, m0, 1024
s_add_u32 s50, s50, 9216
buffer_load_dwordx4 v11, s[24:27], s50 offen nt lds
s_add_u32 m0, m0, 1024
s_add_u32 s50, s50, 9216
buffer_load_dwordx4 v10, s[24:27], s50 offen nt lds
s_waitcnt vmcnt(8)
s_add_u32 m0, m0, 1024
s_add_u32 s50, s50, 9216
buffer_load_dwordx4 v11, s[24:27], s50 offen nt lds
s_waitcnt vmcnt(8)
s_add_u32 m0, m0, 1024
s_add_u32 s50, s50, 9216
buffer_load_dwordx4 v10, s[24:27], s50 offen nt lds
s_waitcnt vmcnt(8)
s_add_u32 m0, m0, 1024
s_add_u32 s50, s50, 9216
buffer_load_dwordx4 v11, s[24:27], s50 offen nt lds
s_waitcnt vmcnt(8)
s_add_u32 m0, m0, 1024
s_add_u32 s50, s50, 9216
buffer_load_dwordx4 v10, s[24:27], s50 offen nt lds
ds_read_b64_tr_b16 v[100:101], v17 offset:0
ds_read_b64_tr_b16 v[102:103], v17 offset:512
ds_read_b64_tr_b16 v[104:105], v18 offset:0
ds_read_b64_tr_b16 v[106:107], v18 offset:512
ds_read_b64_tr_b16 v[108:109], v19 offset:0
ds_read_b64_tr_b16 v[110:111], v19 offset:512
ds_read_b64_tr_b16 v[112:113], v20 offset:0
ds_read_b64_tr_b16 v[114:115], v20 offset:512
s_waitcnt vmcnt(8)
s_add_u32 m0, m0, 1024
s_add_u32 s50, s50, 9216
buffer_load_dwordx4 v11, s[24:27], s50 offen nt lds
s_waitcnt vmcnt(8)
s_add_u32 m0, m0, 1024
s_add_u32 s50, s50, 9216
buffer_load_dwordx4 v10, s[24:27], s50 offen nt lds
s_waitcnt vmcnt(8)
s_add_u32 m0, m0, 1024
s_add_u32 s50, s50, 9216
buffer_load_dwordx4 v11, s[24:27], s50 offen nt lds
s_waitcnt vmcnt(8)
s_add_u32 m0, m0, 1024
s_add_u32 s50, s50, 9216
buffer_load_dwordx4 v10, s[24:27], s50 offen nt lds
ds_read_b64_tr_b16 v[116:117], v17 offset:4096
ds_read_b64_tr_b16 v[118:119], v17 offset:4608
ds_read_b64_tr_b16 v[120:121], v18 offset:4096
ds_read_b64_tr_b16 v[122:123], v18 offset:4608
ds_read_b64_tr_b16 v[124:125], v19 offset:4096
ds_read_b64_tr_b16 v[126:127], v19 offset:4608
ds_read_b64_tr_b16 v[128:129], v20 offset:4096
ds_read_b64_tr_b16 v[130:131], v20 offset:4608
s_waitcnt vmcnt(8)
s_add_u32 m0, m0, 1024
s_add_u32 s50, s50, 9216
buffer_load_dwordx4 v11, s[24:27], s50 offen nt lds
s_waitcnt vmcnt(8)
s_add_u32 m0, m0, 1024
s_add_u32 s50, s50, 9216
buffer_load_dwordx4 v10, s[24:27], s50 offen nt lds
s_waitcnt vmcnt(8)
s_add_u32 m0, m0, 1024
s_add_u32 s50, s50, 9216
buffer_load_dwordx4 v11, s[24:27], s50 offen nt lds
s_waitcnt vmcnt(8)
s_add_u32 m0, m0, 1024
s_add_u32 s50, s50, 9216
buffer_load_dwordx4 v10, s[24:27], s50 offen nt lds
ds_read_b64_tr_b16 v[132:133], v17 offset:8192
ds_read_b64_tr_b16 v[134:135], v17 offset:8704
ds_read_b64_tr_b16 v[136:137], v18 offset:8192
ds_read_b64_tr_b16 v[138:139], v18 offset:8704
ds_read_b64_tr_b16 v[140:141], v19 offset:8192
ds_read_b64_tr_b16 v[142:143], v19 offset:8704
ds_read_b64_tr_b16 v[144:145], v20 offset:8192
ds_read_b64_tr_b16 v[146:147], v20 offset:8704
s_waitcnt vmcnt(8)
s_add_u32 m0, m0, 1024
s_add_u32 s50, s50, 9216
buffer_load_dwordx4 v11, s[24:27], s50 offen nt lds
s_waitcnt vmcnt(8)
s_add_u32 m0, m0, 1024
s_add_u32 s50, s50, 9216
buffer_load_dwordx4 v10, s[24:27], s50 offen nt lds
s_waitcnt vmcnt(8)
s_add_u32 m0, m0, 1024
s_add_u32 s50, s50, 9216
buffer_load_dwordx4 v11, s[24:27], s50 offen nt lds
s_waitcnt vmcnt(8)
s_waitcnt lgkmcnt(0)
s_mov_b32 m0, s51
s_add_u32 s50, s50, 9216
buffer_load_dwordx4 v10, s[24:27], s50 offen nt lds
ds_read_b64_tr_b16 v[148:149], v17 offset:12288
ds_read_b64_tr_b16 v[150:151], v17 offset:12800
ds_read_b64_tr_b16 v[152:153], v18 offset:12288
ds_read_b64_tr_b16 v[154:155], v18 offset:12800
ds_read_b64_tr_b16 v[156:157], v19 offset:12288
ds_read_b64_tr_b16 v[158:159], v19 offset:12800
ds_read_b64_tr_b16 v[160:161], v20 offset:12288
ds_read_b64_tr_b16 v[162:163], v20 offset:12800
s_waitcnt vmcnt(8)
s_add_u32 m0, m0, 1024
s_add_u32 s50, s50, 9216
buffer_load_dwordx4 v11, s[24:27], s50 offen nt lds
s_waitcnt vmcnt(8)
s_add_u32 m0, m0, 1024
s_add_u32 s50, s50, 9216
buffer_load_dwordx4 v10, s[24:27], s50 offen nt lds
s_waitcnt vmcnt(8)
s_add_u32 m0, m0, 1024
s_add_u32 s50, s50, 9216
buffer_load_dwordx4 v11, s[24:27], s50 offen nt lds
s_waitcnt vmcnt(8)
s_waitcnt lgkmcnt(0)
s_add_u32 m0, m0, 1024
s_add_u32 s50, s50, 9216
buffer_load_dwordx4 v10, s[24:27], s50 offen nt lds
ds_read_b64_tr_b16 v[164:165], v17 offset:16384
ds_read_b64_tr_b16 v[166:167], v17 offset:16896
ds_read_b64_tr_b16 v[168:169], v18 offset:16384
ds_read_b64_tr_b16 v[170:171], v18 offset:16896
ds_read_b64_tr_b16 v[172:173], v19 offset:16384
ds_read_b64_tr_b16 v[174:175], v19 offset:16896
ds_read_b64_tr_b16 v[176:177], v20 offset:16384
ds_read_b64_tr_b16 v[178:179], v20 offset:16896
s_waitcnt vmcnt(8)
s_add_u32 m0, m0, 1024
s_add_u32 s50, s50, 9216
buffer_load_dwordx4 v11, s[24:27], s50 offen nt lds
s_waitcnt vmcnt(8)
s_add_u32 m0, m0, 1024
s_add_u32 s50, s50, 9216
buffer_load_dwordx4 v10, s[24:27], s50 offen nt lds
s_waitcnt vmcnt(8)
s_add_u32 m0, m0, 1024
s_add_u32 s50, s50, 9216
buffer_load_dwordx4 v11, s[24:27], s50 offen nt lds
s_waitcnt vmcnt(8)
s_waitcnt lgkmcnt(0)
s_add_u32 m0, m0, 1024
s_add_u32 s50, s50, 9216
buffer_load_dwordx4 v10, s[24:27], s50 offen nt lds
ds_read_b64_tr_b16 v[180:181], v17 offset:20480
ds_read_b64_tr_b16 v[182:183], v17 offset:20992
ds_read_b64_tr_b16 v[184:185], v18 offset:20480
ds_read_b64_tr_b16 v[186:187], v18 offset:20992
ds_read_b64_tr_b16 v[188:189], v19 offset:20480
ds_read_b64_tr_b16 v[190:191], v19 offset:20992
ds_read_b64_tr_b16 v[192:193], v20 offset:20480
ds_read_b64_tr_b16 v[194:195], v20 offset:20992
s_waitcnt vmcnt(8)
s_add_u32 m0, m0, 1024
s_add_u32 s50, s50, 9216
buffer_load_dwordx4 v11, s[24:27], s50 offen nt lds
s_waitcnt vmcnt(8)
s_add_u32 m0, m0, 1024
s_add_u32 s50, s50, 9216
buffer_load_dwordx4 v10, s[24:27], s50 offen nt lds
s_waitcnt vmcnt(8)
s_add_u32 m0, m0, 1024
s_add_u32 s50, s50, 9216
buffer_load_dwordx4 v11, s[24:27], s50 offen nt lds
L_wh:
ds_read_b32 v1, v22 offset:16
s_waitcnt lgkmcnt(0)
v_readfirstlane_b32 s4, v1
s_cmp_lt_u32 s4, 1
s_cbranch_scc1 L_wh
ds_read_b128 v[60:63], v9 offset:0
ds_read_b128 v[64:67], v9 offset:64
ds_read_b128 v[68:71], v9 offset:128
ds_read_b128 v[72:75], v9 offset:192
ds_read_b128 v[76:79], v9 offset:256
ds_read_b128 v[80:83], v9 offset:320
ds_read_b128 v[84:87], v9 offset:384
ds_read_b128 v[88:91], v9 offset:448
ds_read_b128 v[92:95], v9 offset:512
ds_read_b32 v3, v3
ds_read_b32 v21, v21
s_waitcnt lgkmcnt(0)
v_mfma_f32_16x16x32_bf16 v[44:47], v[60:63], v[100:103], 0
v_mfma_f32_16x16x32_bf16 v[48:51], v[60:63], v[104:107], 0
v_mfma_f32_16x16x32_bf16 v[52:55], v[60:63], v[108:111], 0
v_mfma_f32_16x16x32_bf16 v[56:59], v[60:63], v[112:115], 0
v_mfma_f32_16x16x32_bf16 v[44:47], v[64:67], v[116:119], v[44:47]
v_mfma_f32_16x16x32_bf16 v[48:51], v[64:67], v[120:123], v[48:51]
v_mfma_f32_16x16x32_bf16 v[52:55], v[64:67], v[124:127], v[52:55]
v_mfma_f32_16x16x32_bf16 v[56:59], v[64:67], v[128:131], v[56:59]
v_mfma_f32_16x16x32_bf16 v[44:47], v[68:71], v[132:135], v[44:47]
v_mfma_f32_16x16x32_bf16 v[48:51], v[68:71], v[136:139], v[48:51]
v_mfma_f32_16x16x32_bf16 v[52:55], v[68:71], v[140:143], v[52:55]
v_mfma_f32_16x16x32_bf16 v[56:59], v[68:71], v[144:147], v[56:59]
v_mfma_f32_16x16x32_bf16 v[44:47], v[72:75], v[148:151], v[44:47]
v_mfma_f32_16x16x32_bf16 v[48:51], v[72:75], v[152:155], v[48:51]
v_mfma_f32_16x16x32_bf16 v[52:55], v[72:75], v[156:159], v[52:55]
v_mfma_f32_16x16x32_bf16 v[56:59], v[72:75], v[160:163], v[56:59]
v_mfma_f32_16x16x32_bf16 v[44:47], v[76:79], v[164:167], v[44:47]
v_mfma_f32_16x16x32_bf16 v[48:51], v[76:79], v[168:171], v[48:51]
v_mfma_f32_16x16x32_bf16 v[52:55], v[76:79], v[172:175], v[52:55]
v_mfma_f32_16x16x32_bf16 v[56:59], v[76:79], v[176:179], v[56:59]
v_mfma_f32_16x16x32_bf16 v[44:47], v[80:83], v[180:183], v[44:47]
v_mfma_f32_16x16x32_bf16 v[48:51], v[80:83], v[184:187], v[48:51]
v_mfma_f32_16x16x32_bf16 v[52:55], v[80:83], v[188:191], v[52:55]
v_mfma_f32_16x16x32_bf16 v[56:59], v[80:83], v[192:195], v[56:59]
s_waitcnt vmcnt(8)
ds_read_b64_tr_b16 v[196:197], v17 offset:0
ds_read_b64_tr_b16 v[198:199], v17 offset:512
ds_read_b64_tr_b16 v[200:201], v18 offset:0
ds_read_b64_tr_b16 v[202:203], v18 offset:512
ds_read_b64_tr_b16 v[204:205], v19 offset:0
ds_read_b64_tr_b16 v[206:207], v19 offset:512
ds_read_b64_tr_b16 v[208:209], v20 offset:0
ds_read_b64_tr_b16 v[210:211], v20 offset:512
s_waitcnt lgkmcnt(0)
v_mfma_f32_16x16x32_bf16 v[44:47], v[84:87], v[196:199], v[44:47]
v_mfma_f32_16x16x32_bf16 v[48:51], v[84:87], v[200:203], v[48:51]
v_mfma_f32_16x16x32_bf16 v[52:55], v[84:87], v[204:207], v[52:55]
v_mfma_f32_16x16x32_bf16 v[56:59], v[84:87], v[208:211], v[56:59]
s_waitcnt vmcnt(4)
ds_read_b64_tr_b16 v[212:213], v17 offset:4096
ds_read_b64_tr_b16 v[214:215], v17 offset:4608
ds_read_b64_tr_b16 v[216:217], v18 offset:4096
ds_read_b64_tr_b16 v[218:219], v18 offset:4608
ds_read_b64_tr_b16 v[220:221], v19 offset:4096
ds_read_b64_tr_b16 v[222:223], v19 offset:4608
ds_read_b64_tr_b16 v[224:225], v20 offset:4096
ds_read_b64_tr_b16 v[226:227], v20 offset:4608
s_waitcnt lgkmcnt(0)
v_mfma_f32_16x16x32_bf16 v[44:47], v[88:91], v[212:215], v[44:47]
v_mfma_f32_16x16x32_bf16 v[48:51], v[88:91], v[216:219], v[48:51]
v_mfma_f32_16x16x32_bf16 v[52:55], v[88:91], v[220:223], v[52:55]
v_mfma_f32_16x16x32_bf16 v[56:59], v[88:91], v[224:227], v[56:59]
s_waitcnt vmcnt(0)
ds_read_b64_tr_b16 v[228:229], v17 offset:8192
ds_read_b64_tr_b16 v[230:231], v17 offset:8704
ds_read_b64_tr_b16 v[232:233], v18 offset:8192
ds_read_b64_tr_b16 v[234:235], v18 offset:8704
ds_read_b64_tr_b16 v[236:237], v19 offset:8192
ds_read_b64_tr_b16 v[238:239], v19 offset:8704
ds_read_b64_tr_b16 v[240:241], v20 offset:8192
ds_read_b64_tr_b16 v[242:243], v20 offset:8704
s_waitcnt lgkmcnt(0)
v_mfma_f32_16x16x32_bf16 v[44:47], v[92:95], v[228:231], v[44:47]
v_mfma_f32_16x16x32_bf16 v[48:51], v[92:95], v[232:235], v[48:51]
v_mfma_f32_16x16x32_bf16 v[52:55], v[92:95], v[236:239], v[52:55]
v_mfma_f32_16x16x32_bf16 v[56:59], v[92:95], v[240:243], v[56:59]
s_nop 4
v_mul_f32 v4, v3, v44
v_mul_f32 v5, v3, v48
v_mul_f32 v6, v3, v52
v_mul_f32 v7, v3, v56
v_perm_b32 v4, v4, v21, s96
v_perm_b32 v5, v5, v21, s97
v_perm_b32 v6, v6, v21, s98
v_perm_b32 v7, v7, v21, s99
buffer_store_dwordx4 v[4:7], v8, s[32:35], s57 offen sc1
L_fin:
s_endpgm
.p2align 6
L_x:
s_load_dwordx2 s[20:21], s[0:1], 0
s_load_dwordx2 s[40:41], s[0:1], 72
s_load_dwordx2 s[32:33], s[0:1], 96
s_setprio 2
v_and_b32 v0, 63, v0
v_mov_b32 v22, 148640
v_mov_b32 v8, 0
v_mov_b32 v9, 0
ds_write2_b64 v22, v[8:9], v[8:9] offset0:0 offset1:1
ds_write2_b64 v22, v[8:9], v[8:9] offset0:2 offset1:3
ds_write2_b64 v22, v[8:9], v[8:9] offset0:4 offset1:5
s_movk_i32 s22, 0x1200
s_lshl_b32 s23, 1, 17
s_movk_i32 s42, 0x480
s_lshl_b32 s43, 1, 17
v_lshlrev_b32 v1, 4, v0
s_mov_b32 m0, 151552
s_movk_i32 s56, 0x1000
s_waitcnt lgkmcnt(0)
buffer_load_dwordx4 v1, s[20:23], 0 offen lds
buffer_load_dwordx4 v1, s[20:23], 0 offen offset:1024 lds
buffer_load_dwordx4 v1, s[20:23], 0 offen offset:2048 lds
buffer_load_dwordx4 v1, s[20:23], 0 offen offset:3072 lds
s_addk_i32 m0, 0x1000
s_load_dword s48, s[32:33], 0
buffer_load_dwordx4 v1, s[20:23], s56 offen lds
s_addk_i32 m0, 1024
v_mov_b32 v23, 1
buffer_load_dwordx4 v1, s[40:43], 0 offen lds
buffer_load_dwordx4 v1, s[40:43], 0 offen offset:1024 lds
s_barrier
s_mov_b32 s34, 1036288
s_mov_b32 s35, 0x20000
s_mov_b32 s62, 0x05040100
s_mov_b32 s63, 0x07060302
s_mov_b32 s96, 0xffff0000
v_lshrrev_b32 v4, 4, v0
v_and_b32 v5, 15, v0
v_lshlrev_b32 v6, 3, v5
v_mul_u32_u24 v7, 0x480, v4
v_add_u32 v7, v7, v6
v_add_u32 v7, 151552, v7
v_add_u32 v6, 156672, v6
v_add_u32 v2, 139264, v1
s_waitcnt vmcnt(2)
s_mov_b64 exec, 1
ds_add_u32 v22, v23 offset:20
s_mov_b64 exec, -1
s_waitcnt vmcnt(0) lgkmcnt(0)
s_mul_i32 s48, s48, 1664525
s_add_u32 s48, s48, 1013904223
ds_read_b64 v[24:25], v7 offset:0
ds_read_b64 v[44:45], v6 offset:0
ds_read_b64 v[26:27], v7 offset:128
ds_read_b64 v[46:47], v6 offset:128
ds_read_b64 v[28:29], v7 offset:256
ds_read_b64 v[48:49], v6 offset:256
ds_read_b64 v[30:31], v7 offset:384
ds_read_b64 v[50:51], v6 offset:384
ds_read_b64 v[32:33], v7 offset:512
ds_read_b64 v[52:53], v6 offset:512
ds_read_b64 v[34:35], v7 offset:640
ds_read_b64 v[54:55], v6 offset:640
s_waitcnt lgkmcnt(4)
ds_read_b64 v[36:37], v7 offset:768
ds_read_b64 v[56:57], v6 offset:768
ds_read_b64 v[38:39], v7 offset:896
ds_read_b64 v[58:59], v6 offset:896
ds_read_b64 v[40:41], v7 offset:1024
ds_read_b64 v[60:61], v6 offset:1024
s_waitcnt lgkmcnt(8)
v_lshlrev_b32 v12, 16, v24
v_and_b32 v13, s96, v24
v_lshlrev_b32 v14, 16, v44
v_and_b32 v15, s96, v44
v_pk_mul_f32 v[12:13], v[12:13], v[14:15]
v_cvt_pk_bf16_f32 v13, v12, v13
v_lshlrev_b32 v12, 16, v13
v_and_b32 v13, s96, v13
v_pk_add_f32 v[8:9], v[8:9], v[12:13]
v_lshlrev_b32 v12, 16, v25
v_and_b32 v13, s96, v25
v_lshlrev_b32 v14, 16, v45
v_and_b32 v15, s96, v45
v_pk_mul_f32 v[12:13], v[12:13], v[14:15]
v_cvt_pk_bf16_f32 v13, v12, v13
v_lshlrev_b32 v12, 16, v13
v_and_b32 v13, s96, v13
v_pk_add_f32 v[8:9], v[8:9], v[12:13]
v_lshlrev_b32 v12, 16, v26
v_and_b32 v13, s96, v26
v_lshlrev_b32 v14, 16, v46
v_and_b32 v15, s96, v46
v_pk_mul_f32 v[12:13], v[12:13], v[14:15]
v_cvt_pk_bf16_f32 v13, v12, v13
v_lshlrev_b32 v12, 16, v13
v_and_b32 v13, s96, v13
v_pk_add_f32 v[8:9], v[8:9], v[12:13]
v_lshlrev_b32 v12, 16, v27
v_and_b32 v13, s96, v27
v_lshlrev_b32 v14, 16, v47
v_and_b32 v15, s96, v47
v_pk_mul_f32 v[12:13], v[12:13], v[14:15]
v_cvt_pk_bf16_f32 v13, v12, v13
v_lshlrev_b32 v12, 16, v13
v_and_b32 v13, s96, v13
v_pk_add_f32 v[8:9], v[8:9], v[12:13]
v_lshlrev_b32 v12, 16, v28
v_and_b32 v13, s96, v28
v_lshlrev_b32 v14, 16, v48
v_and_b32 v15, s96, v48
v_pk_mul_f32 v[12:13], v[12:13], v[14:15]
v_cvt_pk_bf16_f32 v13, v12, v13
v_lshlrev_b32 v12, 16, v13
v_and_b32 v13, s96, v13
v_pk_add_f32 v[8:9], v[8:9], v[12:13]
v_lshlrev_b32 v12, 16, v29
v_and_b32 v13, s96, v29
v_lshlrev_b32 v14, 16, v49
v_and_b32 v15, s96, v49
v_pk_mul_f32 v[12:13], v[12:13], v[14:15]
v_cvt_pk_bf16_f32 v13, v12, v13
v_lshlrev_b32 v12, 16, v13
v_and_b32 v13, s96, v13
v_pk_add_f32 v[8:9], v[8:9], v[12:13]
v_lshlrev_b32 v12, 16, v30
v_and_b32 v13, s96, v30
v_lshlrev_b32 v14, 16, v50
v_and_b32 v15, s96, v50
v_pk_mul_f32 v[12:13], v[12:13], v[14:15]
v_cvt_pk_bf16_f32 v13, v12, v13
v_lshlrev_b32 v12, 16, v13
v_and_b32 v13, s96, v13
v_pk_add_f32 v[8:9], v[8:9], v[12:13]
v_lshlrev_b32 v12, 16, v31
v_and_b32 v13, s96, v31
v_lshlrev_b32 v14, 16, v51
v_and_b32 v15, s96, v51
v_pk_mul_f32 v[12:13], v[12:13], v[14:15]
v_cvt_pk_bf16_f32 v13, v12, v13
v_lshlrev_b32 v12, 16, v13
v_and_b32 v13, s96, v13
v_pk_add_f32 v[8:9], v[8:9], v[12:13]
s_waitcnt lgkmcnt(0)
v_lshlrev_b32 v12, 16, v32
v_and_b32 v13, s96, v32
v_lshlrev_b32 v14, 16, v52
v_and_b32 v15, s96, v52
v_pk_mul_f32 v[12:13], v[12:13], v[14:15]
v_cvt_pk_bf16_f32 v13, v12, v13
v_lshlrev_b32 v12, 16, v13
v_and_b32 v13, s96, v13
v_pk_add_f32 v[8:9], v[8:9], v[12:13]
v_lshlrev_b32 v12, 16, v33
v_and_b32 v13, s96, v33
v_lshlrev_b32 v14, 16, v53
v_and_b32 v15, s96, v53
v_pk_mul_f32 v[12:13], v[12:13], v[14:15]
v_cvt_pk_bf16_f32 v13, v12, v13
v_lshlrev_b32 v12, 16, v13
v_and_b32 v13, s96, v13
v_pk_add_f32 v[8:9], v[8:9], v[12:13]
v_lshlrev_b32 v12, 16, v34
v_and_b32 v13, s96, v34
v_lshlrev_b32 v14, 16, v54
v_and_b32 v15, s96, v54
v_pk_mul_f32 v[12:13], v[12:13], v[14:15]
v_cvt_pk_bf16_f32 v13, v12, v13
v_lshlrev_b32 v12, 16, v13
v_and_b32 v13, s96, v13
v_pk_add_f32 v[8:9], v[8:9], v[12:13]
v_lshlrev_b32 v12, 16, v35
v_and_b32 v13, s96, v35
v_lshlrev_b32 v14, 16, v55
v_and_b32 v15, s96, v55
v_pk_mul_f32 v[12:13], v[12:13], v[14:15]
v_cvt_pk_bf16_f32 v13, v12, v13
v_lshlrev_b32 v12, 16, v13
v_and_b32 v13, s96, v13
v_pk_add_f32 v[8:9], v[8:9], v[12:13]
v_lshlrev_b32 v12, 16, v36
v_and_b32 v13, s96, v36
v_lshlrev_b32 v14, 16, v56
v_and_b32 v15, s96, v56
v_pk_mul_f32 v[12:13], v[12:13], v[14:15]
v_cvt_pk_bf16_f32 v13, v12, v13
v_lshlrev_b32 v12, 16, v13
v_and_b32 v13, s96, v13
v_pk_add_f32 v[8:9], v[8:9], v[12:13]
v_lshlrev_b32 v12, 16, v37
v_and_b32 v13, s96, v37
v_lshlrev_b32 v14, 16, v57
v_and_b32 v15, s96, v57
v_pk_mul_f32 v[12:13], v[12:13], v[14:15]
v_cvt_pk_bf16_f32 v13, v12, v13
v_lshlrev_b32 v12, 16, v13
v_and_b32 v13, s96, v13
v_pk_add_f32 v[8:9], v[8:9], v[12:13]
v_lshlrev_b32 v12, 16, v38
v_and_b32 v13, s96, v38
v_lshlrev_b32 v14, 16, v58
v_and_b32 v15, s96, v58
v_pk_mul_f32 v[12:13], v[12:13], v[14:15]
v_cvt_pk_bf16_f32 v13, v12, v13
v_lshlrev_b32 v12, 16, v13
v_and_b32 v13, s96, v13
v_pk_add_f32 v[8:9], v[8:9], v[12:13]
v_lshlrev_b32 v12, 16, v39
v_and_b32 v13, s96, v39
v_lshlrev_b32 v14, 16, v59
v_and_b32 v15, s96, v59
v_pk_mul_f32 v[12:13], v[12:13], v[14:15]
v_cvt_pk_bf16_f32 v13, v12, v13
v_lshlrev_b32 v12, 16, v13
v_and_b32 v13, s96, v13
v_pk_add_f32 v[8:9], v[8:9], v[12:13]
v_lshlrev_b32 v12, 16, v40
v_and_b32 v13, s96, v40
v_lshlrev_b32 v14, 16, v60
v_and_b32 v15, s96, v60
v_pk_mul_f32 v[12:13], v[12:13], v[14:15]
v_cvt_pk_bf16_f32 v13, v12, v13
v_lshlrev_b32 v12, 16, v13
v_and_b32 v13, s96, v13
v_pk_add_f32 v[8:9], v[8:9], v[12:13]
v_lshlrev_b32 v12, 16, v41
v_and_b32 v13, s96, v41
v_lshlrev_b32 v14, 16, v61
v_and_b32 v15, s96, v61
v_pk_mul_f32 v[12:13], v[12:13], v[14:15]
v_cvt_pk_bf16_f32 v13, v12, v13
v_lshlrev_b32 v12, 16, v13
v_and_b32 v13, s96, v13
v_pk_add_f32 v[8:9], v[8:9], v[12:13]
v_add_f32 v8, v8, v9
s_nop 1
v_add_f32_dpp v8, v8, v8 row_ror:8 row_mask:0xf bank_mask:0xf
s_nop 1
v_add_f32_dpp v8, v8, v8 row_ror:4 row_mask:0xf bank_mask:0xf
s_nop 1
v_add_f32_dpp v8, v8, v8 row_ror:2 row_mask:0xf bank_mask:0xf
s_nop 1
v_add_f32_dpp v8, v8, v8 row_ror:1 row_mask:0xf bank_mask:0xf
v_cvt_pk_bf16_f32 v8, v8, v8
v_and_b32 v8, s96, v8
v_mul_f32 v8, 0xbfb8aa3b, v8
v_exp_f32 v8, v8
s_getreg_b32 s53, hwreg(HW_REG_XCC_ID, 0, 4)
v_add_f32 v8, 1.0, v8
v_rcp_f32 v8, v8
v_mov_b32 v20, s53
v_cvt_pk_bf16_f32 v8, v8, v8
v_and_b32 v19, s96, v8
v_mov_b32 v3, s48
v_sub_f32 v8, 1.0, v19
v_cvt_pk_bf16_f32 v8, v8, v8
v_and_b32 v8, s96, v8
v_lshlrev_b32 v9, 2, v4
v_add_u32 v9, 147968, v9
ds_write2_b32 v9, v19, v8 offset0:0 offset1:4
v_mov_b32 v9, 148000
ds_write_b32 v9, v3
v_lshlrev_b32 v10, 10, v4
v_lshl_add_u32 v10, v5, 4, v10
v_lshlrev_b32 v11, 7, v4
v_lshl_add_u32 v11, v5, 1, v11
v_add_u32 v11, 147456, v11
s_lshr_b32 s57, s45, 2
s_lshl4_add_u32 s60, s44, s57
s_lshl_b32 s60, s60, 8
s_add_u32 s60, s60, 4096
s_cmp_ge_u32 s45, 13
s_cbranch_scc1 L_x_nop1
s_lshl2_add_u32 s56, s44, s45
s_mul_i32 s57, s47, 9
s_add_u32 s57, s57, s45
s_mul_i32 s50, s49, 72
s_add_u32 s57, s57, s50
s_add_u32 s57, s57, 60
s_cmp_lt_u32 s45, 4
s_cselect_b32 s50, s56, s57
s_lshl_b32 s50, s50, 10
s_add_u32 s50, s50, 4096
L_w1:
ds_read_b32 v12, v22 offset:0
s_waitcnt lgkmcnt(0)
v_readfirstlane_b32 s4, v12
s_cmp_lt_u32 s4, 4
s_cbranch_scc1 L_w1
ds_read_b128 v[24:27], v2 offset:0
ds_read_b128 v[28:31], v2 offset:1024
ds_read_b128 v[32:35], v2 offset:2048
ds_read_b128 v[36:39], v2 offset:3072
s_waitcnt lgkmcnt(2)
v_pk_add_f32 v[24:25], v[24:25], v[28:29]
v_pk_add_f32 v[26:27], v[26:27], v[30:31]
s_waitcnt lgkmcnt(0)
v_pk_add_f32 v[32:33], v[32:33], v[36:37]
v_pk_add_f32 v[34:35], v[34:35], v[38:39]
v_pk_add_f32 v[24:25], v[24:25], v[32:33]
v_pk_add_f32 v[26:27], v[26:27], v[34:35]
v_cvt_pk_bf16_f32 v24, v24, v25
v_cvt_pk_bf16_f32 v26, v26, v27
v_perm_b32 v12, v24, v3, s62
v_perm_b32 v13, v24, v3, s63
v_perm_b32 v14, v26, v20, s62
v_perm_b32 v15, v26, v20, s63
buffer_store_dwordx4 v[12:15], v1, s[32:35], s50 offen sc1
L_x_nop1:
s_mov_b32 s59, 0
L_sq:
s_load_dword s8, s[32:33], s60 glc
s_load_dword s9, s[32:33], s60 offset:1024 glc
s_load_dword s10, s[32:33], s60 offset:2048 glc
s_load_dword s11, s[32:33], s60 offset:3072 glc
s_add_u32 s59, s59, 1
s_cmp_gt_u32 s59, 100000
s_cbranch_scc1 L_sq_out
s_waitcnt lgkmcnt(0)
s_xor_b32 s8, s8, s48
s_xor_b32 s9, s9, s48
s_or_b32 s8, s8, s9
s_xor_b32 s10, s10, s48
s_or_b32 s8, s8, s10
s_xor_b32 s11, s11, s48
s_or_b32 s8, s8, s11
s_and_b32 s8, s8, 0xffff
s_cbranch_scc1 L_sq
L_sq_out:
s_waitcnt lgkmcnt(0)
s_mov_b32 s59, 0
L_pq:
buffer_load_dwordx4 v[24:27], v10, s[32:35], s60 offen sc1
s_waitcnt vmcnt(0)
v_perm_b32 v16, v25, v24, s62
v_xor_b32 v16, v16, v3
v_cmp_ne_u32 vcc, 0, v16
s_add_u32 s59, s59, 1
s_cmp_gt_u32 s59, 100000
s_cbranch_scc1 L_pq_out
s_cbranch_vccnz L_pq
L_pq_out:
ds_write_b16_d16_hi v11, v24 offset:0
ds_write_b16_d16_hi v11, v25 offset:32
ds_write_b16_d16_hi v11, v26 offset:64
ds_write_b16_d16_hi v11, v27 offset:96
v_readfirstlane_b32 s7, v26
s_and_b32 s7, s7, 0xffff
s_xor_b32 s7, s7, s53
s_cselect_b32 s4, 3, 1
v_mov_b32 v16, s4
s_mov_b64 exec, 1
ds_add_u32 v22, v16 offset:8
s_mov_b64 exec, -1
s_cmp_lt_u32 s45, 13
s_cbranch_scc1 L_x_noh
s_mul_i32 s56, s47, 9
s_lshl2_add_u32 s56, s49, s56
s_lshl_b32 s56, s56, 10
s_add_u32 s56, s56, 69632
s_add_u32 s57, s56, 4096
s_add_u32 s50, s56, 73728
s_add_u32 s51, s50, 4096
s_mov_b32 s98, s56
s_mov_b32 s99, s50
s_mov_b32 s100, s57
s_mov_b32 s101, s51
buffer_load_dwordx4 v[64:67], v1, s[32:35], s98 offen sc1
buffer_load_dwordx4 v[68:71], v1, s[32:35], s99 offen sc1
buffer_load_dwordx4 v[72:75], v1, s[32:35], s98 offen offset:1024 sc1
buffer_load_dwordx4 v[76:79], v1, s[32:35], s99 offen offset:1024 sc1
buffer_load_dwordx4 v[80:83], v1, s[32:35], s98 offen offset:2048 sc1
buffer_load_dwordx4 v[84:87], v1, s[32:35], s99 offen offset:2048 sc1
buffer_load_dwordx4 v[88:91], v1, s[32:35], s98 offen offset:3072 sc1
buffer_load_dwordx4 v[92:95], v1, s[32:35], s99 offen offset:3072 sc1
buffer_load_dwordx4 v[96:99], v1, s[32:35], s100 offen sc1
buffer_load_dwordx4 v[100:103], v1, s[32:35], s101 offen sc1
L_x_noh:
v_lshrrev_b32 v8, 5, v0
v_lshlrev_b32 v8, 4, v8
v_add_u32 v8, 148544, v8
v_add_u32 v2, 143360, v1
v_lshlrev_b32 v9, 12, v4
v_lshl_add_u32 v9, v5, 4, v9
s_and_b32 s57, s45, 3
s_lshl4_add_u32 s56, s44, s57
s_lshr_b32 s51, s45, 2
s_lshl2_add_u32 s56, s56, s51
s_lshl_b32 s56, s56, 8
s_add_u32 s56, s56, 217088
s_add_u32 s52, s56, 557056
L_ws:
ds_read_b32 v16, v22 offset:24
ds_read_b128 v[12:15], v8
ds_read_b128 v[40:43], v8 offset:32
s_waitcnt lgkmcnt(2)
v_readfirstlane_b32 s4, v16
s_cmp_lt_u32 s4, 4
s_cbranch_scc1 L_ws
s_waitcnt lgkmcnt(0)
v_max3_f32 v10, v12, v13, v14
v_max_f32 v10, v10, v15
v_sub_f32 v12, v12, v10
v_sub_f32 v13, v13, v10
v_sub_f32 v14, v14, v10
v_sub_f32 v15, v15, v10
v_exp_f32 v12, v12
v_exp_f32 v13, v13
v_exp_f32 v14, v14
v_exp_f32 v15, v15
s_nop 0
v_mul_f32 v40, v12, v40
v_fmac_f32 v40, v13, v41
v_fmac_f32 v40, v14, v42
v_fmac_f32 v40, v15, v43
v_rcp_f32 v41, v40
v_log_f32 v40, v40
s_nop 0
v_mul_f32 v12, v41, v12
v_mul_f32 v13, v41, v13
v_mul_f32 v14, v41, v14
v_mul_f32 v15, v41, v15
v_add_f32 v10, v10, v40
s_cmp_lg_u32 s7, 0
s_cselect_b32 s4, 1, 0
v_xor_b32 v50, s4, v3
v_mov_b32 v51, v10
L_wo:
ds_read_b32 v16, v22 offset:12
ds_read_b128 v[24:27], v2 offset:0
ds_read_b128 v[28:31], v2 offset:1024
ds_read_b128 v[32:35], v2 offset:2048
ds_read_b128 v[36:39], v2 offset:3072
s_waitcnt lgkmcnt(4)
v_readfirstlane_b32 s4, v16
s_cmp_lt_u32 s4, 4
s_cbranch_scc1 L_wo
s_waitcnt lgkmcnt(3)
v_pk_mul_f32 v[24:25], v[24:25], v[12:13] op_sel:[0,0] op_sel_hi:[1,0]
v_pk_mul_f32 v[26:27], v[26:27], v[12:13] op_sel:[0,0] op_sel_hi:[1,0]
s_waitcnt lgkmcnt(2)
v_pk_fma_f32 v[24:25], v[28:29], v[12:13], v[24:25] op_sel:[0,1,0] op_sel_hi:[1,1,1]
v_pk_fma_f32 v[26:27], v[30:31], v[12:13], v[26:27] op_sel:[0,1,0] op_sel_hi:[1,1,1]
s_waitcnt lgkmcnt(1)
v_pk_fma_f32 v[24:25], v[32:33], v[14:15], v[24:25] op_sel:[0,0,0] op_sel_hi:[1,0,1]
v_pk_fma_f32 v[26:27], v[34:35], v[14:15], v[26:27] op_sel:[0,0,0] op_sel_hi:[1,0,1]
s_waitcnt lgkmcnt(0)
v_pk_fma_f32 v[24:25], v[36:37], v[14:15], v[24:25] op_sel:[0,1,0] op_sel_hi:[1,1,1]
v_pk_fma_f32 v[26:27], v[38:39], v[14:15], v[26:27] op_sel:[0,1,0] op_sel_hi:[1,1,1]
v_cvt_pk_bf16_f32 v48, v24, v25
v_cvt_pk_bf16_f32 v49, v26, v27
s_cmp_lg_u32 s7, 0
s_cbranch_scc1 L_pub_far
buffer_store_dwordx4 v[48:51], v9, s[32:35], s56 offen
L_pub_d:
s_mov_b64 exec, 1
ds_add_u32 v22, v23 offset:28
s_mov_b64 exec, -1
s_cmp_lt_u32 s45, 13
s_cbranch_scc1 L_fin
s_waitcnt vmcnt(10)
v_perm_b32 v17, v65, v64, s62
v_xor_b32 v16, v17, v3
s_waitcnt vmcnt(9)
v_perm_b32 v17, v69, v68, s62
v_xor_b32 v17, v17, v3
v_or_b32 v16, v16, v17
s_waitcnt vmcnt(8)
v_perm_b32 v17, v73, v72, s62
v_xor_b32 v17, v17, v3
v_or_b32 v16, v16, v17
s_waitcnt vmcnt(7)
v_perm_b32 v17, v77, v76, s62
v_xor_b32 v17, v17, v3
v_or_b32 v16, v16, v17
s_waitcnt vmcnt(6)
v_perm_b32 v17, v81, v80, s62
v_xor_b32 v17, v17, v3
v_or_b32 v16, v16, v17
s_waitcnt vmcnt(5)
v_perm_b32 v17, v85, v84, s62
v_xor_b32 v17, v17, v3
v_or_b32 v16, v16, v17
s_waitcnt vmcnt(4)
v_perm_b32 v17, v89, v88, s62
v_xor_b32 v17, v17, v3
v_or_b32 v16, v16, v17
s_waitcnt vmcnt(3)
v_perm_b32 v17, v93, v92, s62
v_xor_b32 v17, v17, v3
v_or_b32 v16, v16, v17
s_waitcnt vmcnt(2)
v_perm_b32 v17, v97, v96, s62
v_xor_b32 v17, v17, v3
v_or_b32 v16, v16, v17
s_waitcnt vmcnt(1)
v_perm_b32 v17, v101, v100, s62
v_xor_b32 v17, v17, v3
v_or_b32 v16, v16, v17
v_cmp_ne_u32 vcc, 0, v16
s_cbranch_vccz L_ph_out
s_mov_b32 s59, 0
L_ph:
buffer_load_dwordx4 v[64:67], v1, s[32:35], s98 offen sc1
buffer_load_dwordx4 v[68:71], v1, s[32:35], s99 offen sc1
buffer_load_dwordx4 v[72:75], v1, s[32:35], s98 offen offset:1024 sc1
buffer_load_dwordx4 v[76:79], v1, s[32:35], s99 offen offset:1024 sc1
buffer_load_dwordx4 v[80:83], v1, s[32:35], s98 offen offset:2048 sc1
buffer_load_dwordx4 v[84:87], v1, s[32:35], s99 offen offset:2048 sc1
buffer_load_dwordx4 v[88:91], v1, s[32:35], s98 offen offset:3072 sc1
buffer_load_dwordx4 v[92:95], v1, s[32:35], s99 offen offset:3072 sc1
buffer_load_dwordx4 v[96:99], v1, s[32:35], s100 offen sc1
buffer_load_dwordx4 v[100:103], v1, s[32:35], s101 offen sc1
s_waitcnt vmcnt(9)
v_perm_b32 v17, v65, v64, s62
v_xor_b32 v16, v17, v3
s_waitcnt vmcnt(8)
v_perm_b32 v17, v69, v68, s62
v_xor_b32 v17, v17, v3
v_or_b32 v16, v16, v17
s_waitcnt vmcnt(7)
v_perm_b32 v17, v73, v72, s62
v_xor_b32 v17, v17, v3
v_or_b32 v16, v16, v17
s_waitcnt vmcnt(6)
v_perm_b32 v17, v77, v76, s62
v_xor_b32 v17, v17, v3
v_or_b32 v16, v16, v17
s_waitcnt vmcnt(5)
v_perm_b32 v17, v81, v80, s62
v_xor_b32 v17, v17, v3
v_or_b32 v16, v16, v17
s_waitcnt vmcnt(4)
v_perm_b32 v17, v85, v84, s62
v_xor_b32 v17, v17, v3
v_or_b32 v16, v16, v17
s_waitcnt vmcnt(3)
v_perm_b32 v17, v89, v88, s62
v_xor_b32 v17, v17, v3
v_or_b32 v16, v16, v17
s_waitcnt vmcnt(2)
v_perm_b32 v17, v93, v92, s62
v_xor_b32 v17, v17, v3
v_or_b32 v16, v16, v17
s_waitcnt vmcnt(1)
v_perm_b32 v17, v97, v96, s62
v_xor_b32 v17, v17, v3
v_or_b32 v16, v16, v17
s_waitcnt vmcnt(0)
v_perm_b32 v17, v101, v100, s62
v_xor_b32 v17, v17, v3
v_or_b32 v16, v16, v17
v_cmp_ne_u32 vcc, 0, v16
s_add_u32 s59, s59, 1
s_cmp_gt_u32 s59, 100000
s_cbranch_scc1 L_ph_out
s_cbranch_vccnz L_ph
L_ph_out:
v_mul_u32_u24 v9, 656, v4
v_lshl_add_u32 v9, v5, 1, v9
v_add_u32 v9, 148736, v9
v_and_b32 v64, s96, v64
v_and_b32 v65, s96, v65
v_and_b32 v66, s96, v66
v_and_b32 v67, s96, v67
v_and_b32 v68, s96, v68
v_and_b32 v69, s96, v69
v_and_b32 v70, s96, v70
v_and_b32 v71, s96, v71
v_max_f32 v64, 0, v64
v_max_f32 v65, 0, v65
v_max_f32 v66, 0, v66
v_max_f32 v67, 0, v67
v_mul_f32 v64, v64, v68
v_mul_f32 v65, v65, v69
v_mul_f32 v66, v66, v70
v_mul_f32 v67, v67, v71
v_cvt_pk_bf16_f32 v64, v64, v65
v_cvt_pk_bf16_f32 v66, v66, v67
ds_write_b16 v9, v64 offset:0
ds_write_b16_d16_hi v9, v64 offset:32
ds_write_b16 v9, v66 offset:64
ds_write_b16_d16_hi v9, v66 offset:96
v_and_b32 v72, s96, v72
v_and_b32 v73, s96, v73
v_and_b32 v74, s96, v74
v_and_b32 v75, s96, v75
v_and_b32 v76, s96, v76
v_and_b32 v77, s96, v77
v_and_b32 v78, s96, v78
v_and_b32 v79, s96, v79
v_max_f32 v72, 0, v72
v_max_f32 v73, 0, v73
v_max_f32 v74, 0, v74
v_max_f32 v75, 0, v75
v_mul_f32 v72, v72, v76
v_mul_f32 v73, v73, v77
v_mul_f32 v74, v74, v78
v_mul_f32 v75, v75, v79
v_cvt_pk_bf16_f32 v72, v72, v73
v_cvt_pk_bf16_f32 v74, v74, v75
ds_write_b16 v9, v72 offset:128
ds_write_b16_d16_hi v9, v72 offset:160
ds_write_b16 v9, v74 offset:192
ds_write_b16_d16_hi v9, v74 offset:224
v_and_b32 v80, s96, v80
v_and_b32 v81, s96, v81
v_and_b32 v82, s96, v82
v_and_b32 v83, s96, v83
v_and_b32 v84, s96, v84
v_and_b32 v85, s96, v85
v_and_b32 v86, s96, v86
v_and_b32 v87, s96, v87
v_max_f32 v80, 0, v80
v_max_f32 v81, 0, v81
v_max_f32 v82, 0, v82
v_max_f32 v83, 0, v83
v_mul_f32 v80, v80, v84
v_mul_f32 v81, v81, v85
v_mul_f32 v82, v82, v86
v_mul_f32 v83, v83, v87
v_cvt_pk_bf16_f32 v80, v80, v81
v_cvt_pk_bf16_f32 v82, v82, v83
ds_write_b16 v9, v80 offset:256
ds_write_b16_d16_hi v9, v80 offset:288
ds_write_b16 v9, v82 offset:320
ds_write_b16_d16_hi v9, v82 offset:352
v_and_b32 v88, s96, v88
v_and_b32 v89, s96, v89
v_and_b32 v90, s96, v90
v_and_b32 v91, s96, v91
v_and_b32 v92, s96, v92
v_and_b32 v93, s96, v93
v_and_b32 v94, s96, v94
v_and_b32 v95, s96, v95
v_max_f32 v88, 0, v88
v_max_f32 v89, 0, v89
v_max_f32 v90, 0, v90
v_max_f32 v91, 0, v91
v_mul_f32 v88, v88, v92
v_mul_f32 v89, v89, v93
v_mul_f32 v90, v90, v94
v_mul_f32 v91, v91, v95
v_cvt_pk_bf16_f32 v88, v88, v89
v_cvt_pk_bf16_f32 v90, v90, v91
ds_write_b16 v9, v88 offset:384
ds_write_b16_d16_hi v9, v88 offset:416
ds_write_b16 v9, v90 offset:448
ds_write_b16_d16_hi v9, v90 offset:480
v_and_b32 v96, s96, v96
v_and_b32 v97, s96, v97
v_and_b32 v98, s96, v98
v_and_b32 v99, s96, v99
v_and_b32 v100, s96, v100
v_and_b32 v101, s96, v101
v_and_b32 v102, s96, v102
v_and_b32 v103, s96, v103
v_max_f32 v96, 0, v96
v_max_f32 v97, 0, v97
v_max_f32 v98, 0, v98
v_max_f32 v99, 0, v99
v_mul_f32 v96, v96, v100
v_mul_f32 v97, v97, v101
v_mul_f32 v98, v98, v102
v_mul_f32 v99, v99, v103
v_cvt_pk_bf16_f32 v96, v96, v97
v_cvt_pk_bf16_f32 v98, v98, v99
ds_write_b16 v9, v96 offset:512
ds_write_b16_d16_hi v9, v96 offset:544
ds_write_b16 v9, v98 offset:576
ds_write_b16_d16_hi v9, v98 offset:608
s_mov_b64 exec, 1
ds_add_u32 v22, v23 offset:16
s_mov_b64 exec, -1
s_endpgm
L_pub_far:
buffer_store_dwordx4 v[48:51], v9, s[32:35], s56 offen sc1
s_branch L_pub_d
L_exit:
s_endpgm
L_code_end:
.section .rodata,"a"
.p2align 6
.amdhsa_kernel gated_mix__sliding_block_cached__glu_gated_reglu__decode_kernel
  .amdhsa_next_free_vgpr 248
  .amdhsa_next_free_sgpr 102
  .amdhsa_accum_offset 248
  .amdhsa_group_segment_fixed_size 0
  .amdhsa_kernarg_size 104
  .amdhsa_user_sgpr_count 2
  .amdhsa_user_sgpr_kernarg_segment_ptr 1
  .amdhsa_system_sgpr_workgroup_id_x 1
  .amdhsa_float_denorm_mode_32 3
.end_amdhsa_kernel
```
